```python
import torch

def _softmax(x, axis=-1):
    return torch.softmax(x, dim=axis)

def _gelu(x):
    return torch.nn.functional.gelu(x, approximate='tanh')

def _silu(x):
    return torch.nn.functional.silu(x)

def _sigmoid(x):
    return torch.sigmoid(x)

def _layernorm(x, axis=-1, eps=1e-05):
    m = x.mean(dim=axis, keepdim=True)
    v = x.var(dim=axis, keepdim=True, unbiased=False)
    return (x - m) / torch.sqrt(v + eps)

def _scatter_add(tgt, idx, src, axis=0):
    return tgt.clone().index_add_(axis, idx, src)

def _segment_sum(src, seg, n):
    out = torch.zeros((n,) + src.shape[1:], dtype=src.dtype)
    return out.index_add_(0, seg, src)

def _pad(x, pw):
    flat = tuple((v for pair in reversed(pw) for v in pair))
    return torch.nn.functional.pad(x, flat)
kernel_name = 'adaLN_cond__ssm_conv_h3__moe_arch_mod__prompt'

def setup_inputs():

    _w = lambda a: (lambda t: t.to(torch.bfloat16) if t.is_floating_point() else t)(torch.as_tensor(a))

    def _A_setup():
        B, S, D = (1, 2048, 640)
        ks = 4
        return {'q': _w((lambda *s: torch.randn(*s, dtype=torch.bfloat16) * 0.05)(B, S, D)), 'k': _w((lambda *s: torch.randn(*s, dtype=torch.bfloat16) * 0.4)(B, S, D)), 'v': _w((lambda *s: torch.randn(*s, dtype=torch.bfloat16) * 0.4)(B, S, D)), 'shift_k': _w((lambda *s: torch.randn(*s, dtype=torch.bfloat16) * 0.4)(D, ks) * 0.5), 'ssm_k': _w((lambda *s: torch.randn(*s, dtype=torch.bfloat16) * 0.8)(D, S) * (1.0 / S ** 0.5)), 'ssm_D': _w((lambda *s: torch.randn(*s, dtype=torch.bfloat16) * 0.4)(D))}
    _A_in = _A_setup()

    def _B_setup():
        B, S, D, F, C = (1, 2048, 640, 1728, 1)
        return {'x': _w((lambda *s: torch.randn(*s, dtype=torch.bfloat16) * 0.05)(B, S, D)), 'w_r': _w((lambda *s: torch.randn(*s, dtype=torch.bfloat16) * 0.05)(D)), 'w_gate': _w((lambda *s: torch.randn(*s, dtype=torch.bfloat16) * 0.05)(D, F)), 'w_up': _w((lambda *s: torch.randn(*s, dtype=torch.bfloat16) * 0.05)(D, F)), 'w_down': _w((lambda *s: torch.randn(*s, dtype=torch.bfloat16) * 0.05)(F, D))}
    _B_in = _B_setup()
    return {'A_q': _A_in['q'], 'A_k': _A_in['k'], 'A_v': _A_in['v'], 'A_shift_k': _A_in['shift_k'], 'A_ssm_k': _A_in['ssm_k'], 'A_ssm_D': _A_in['ssm_D'], 'B_x': _B_in['x'], 'B_w_r': _B_in['w_r'], 'B_w_gate': _B_in['w_gate'], 'B_w_up': _B_in['w_up'], 'B_w_down': _B_in['w_down'], 'c': _w((lambda *s: torch.randn(*s, dtype=torch.bfloat16) * 0.2)(1, 640) * 8.0), 'w_mod': _w((lambda *s: torch.randn(*s, dtype=torch.bfloat16) * 0.2)(640, 6 * 640) * 640 ** (-0.5) * 8.0)}

def reference(A_q, A_k, A_v, A_shift_k, A_ssm_k, A_ssm_D, B_x, B_w_r, B_w_gate, B_w_up, B_w_down, c, w_mod):

    def _A_ref(q, k, v, shift_k, ssm_k, ssm_D):
        B, S, D = q.shape
        ks = shift_k.shape[-1]
        k_pad = _pad(k, ((0, 0), (ks - 1, 0), (0, 0)))
        k_shift = torch.zeros_like(k)
        for t in range(ks):
            k_shift = k_shift + k_pad[:, t:t + S, :] * shift_k[:, ks - 1 - t][None, None, :]
        kv = k_shift * v
        L = 2 * S
        kv_pad = _pad(kv, ((0, 0), (0, S), (0, 0)))
        kf_pad = _pad(ssm_k, ((0, 0), (0, S)))
        kv_f = (lambda x, axes=(-2, -1): torch.fft.rfft2(x.float(), dim=axes))(kv_pad[:, None, :, :], axes=(1, 2))
        kf_f = (lambda x, axes=(-2, -1): torch.fft.rfft2(x.float(), dim=axes))(kf_pad[:, None, :], axes=(1, 2))
        kf_f = (lambda x, *d: x.permute(*d))(kf_f, 1, 2, 0)
        y_f = kv_f * kf_f[None, :, :, :]
        y = (lambda x, s, axes=(-2, -1): torch.fft.irfft2(x, s=s, dim=axes).to(torch.bfloat16))(y_f, (1, L), axes=(1, 2))[:, 0, :S, :]
        y = y + kv * ssm_D[None, None, :]
        return q * y

    def _B_ref(x, w_r, w_gate, w_up, w_down):
        B, S, D = x.shape
        C = 1
        r = x @ w_r
        idx = torch.argsort(-r, axis=-1)[:, :C]
        idx_e = (lambda x, n, axis: torch.repeat_interleave(x, n, dim=axis))(idx.reshape(B, C, 1), D, axis=2)
        x_sel = (lambda x, i, axis: torch.take_along_dim(x, i, dim=axis))(x, idx_e, axis=1)
        g = _silu(x_sel @ w_gate)
        u = x_sel @ w_up
        y = g * u @ w_down
        r_sel = _sigmoid((lambda x, i, axis: torch.take_along_dim(x, i, dim=axis))(r, idx, axis=1))
        y = y * r_sel.reshape(B, C, 1)
        b_off = (torch.arange(B) * S).reshape(B, 1)
        flat_idx = (idx + b_off).reshape(B * C)
        zero = (x * 0.0).reshape(B * S, D)
        upd = _scatter_add(zero, flat_idx, y.reshape(B * C, D), axis=0)
        return x + upd.reshape(B, S, D)
    x = A_q
    mod = (_silu(c) @ w_mod).reshape(c.shape[0], 6, 1, -1)
    sa, ca, ga, sb, cb, gb = (mod[:, 0].clone(), mod[:, 1].clone(), mod[:, 2].clone(), mod[:, 3].clone(), mod[:, 4].clone(), mod[:, 5].clone())
    h = _layernorm(x, axis=-1) * (1 + ca) + sa
    x = x + ga * _A_ref(h, A_k, A_v, A_shift_k, A_ssm_k, A_ssm_D)
    h = _layernorm(x, axis=-1) * (1 + cb) + sb
    x = x + gb * _B_ref(h, B_w_r, B_w_gate, B_w_up, B_w_down)
    return x
```

```asm
; @launch grid=(256,1,1) block=(640,1,1) lds=159744
.amdgcn_target "amdgcn-amd-amdhsa--gfx950"
.text
.globl adaLN_cond__ssm_conv_h3__moe_arch_mod__prompt_kernel
.p2align 8
.type adaLN_cond__ssm_conv_h3__moe_arch_mod__prompt_kernel,@function
adaLN_cond__ssm_conv_h3__moe_arch_mod__prompt_kernel:
    s_getpc_b64 s[66:67]
    s_load_dwordx2 s[4:5], s[0:1], 8
    s_load_dwordx2 s[8:9], s[0:1], 16
    s_load_dwordx2 s[12:13], s[0:1], 24
    s_load_dwordx2 s[16:17], s[0:1], 120
    s_load_dwordx2 s[20:21], s[0:1], 32
    s_cmp_ge_u32 s2, 256
    s_cbranch_scc1 L_exit
    s_sub_u32 s72, s2, 216
    s_cmp_lt_u32 s72, 40
    s_cbranch_scc0 L_pfdone
    s_lshr_b32 s72, s72, 3
    v_mad_u32_u24 v43, v0, 5, s72
    v_lshlrev_b32 v43, 7, v43
    v_cmp_gt_u32 vcc, L_code_end-adaLN_cond__ssm_conv_h3__moe_arch_mod__prompt_kernel-8, v43
    s_and_saveexec_b64 s[68:69], vcc
    s_cbranch_execz L_nopf
    v_mov_b32 v165, s67
    v_add_co_u32 v164, vcc, s66, v43
    s_nop 1
    v_addc_co_u32 v165, vcc, 0, v165, vcc
    global_load_dword v163, v[164:165], off
L_nopf:
    s_mov_b64 exec, -1
L_pfdone:
    v_readfirstlane_b32 s62, v0
    s_lshr_b32 s74, s2, 3
    v_bfe_u32 v2, v0, 4, 2
    v_and_b32 v3, 15, v0
    s_lshr_b32 s61, s62, 6
    s_lshl3_add_u32 s71, s2, s61
    s_cmp_lt_u32 s61, 8
    s_cselect_b32 s58, s71, -1
    s_mul_i32 s70, s71, 3277
    s_lshr_b32 s70, s70, 16
    s_mul_i32 s72, s70, 20
    s_sub_u32 s71, s71, s72
    s_mul_i32 s72, s70, 30720
    s_lshl_b32 s73, s71, 6
    s_add_u32 s72, s72, s73
    v_mul_u32_u24 v40, 7680, v2
    v_lshl_add_u32 v40, v3, 2, v40
    v_add_u32 v40, s72, v40
    v_subrev_u32 v41, 3840, v40
    v_add_u32 v43, 3840, v40
    v_lshlrev_b32 v42, 4, v3
    s_lshl_b32 s73, s73, 2
    s_mov_b32 s6, 2621440
    s_mov_b32 s7, 0x20000
    s_mov_b64 s[10:11], s[6:7]
    s_movk_i32 s14, 5120
    s_mov_b32 s15, s7
    s_cmpk_ge_u32 s58, 1720
    s_waitcnt lgkmcnt(0)
    s_cbranch_scc1 L_shadow
    buffer_load_dwordx4 v[112:115], v42, s[12:15], s73 offen
    buffer_load_dword v96, v41, s[4:7], 0 offen offset:0
    buffer_load_dword v97, v41, s[4:7], 0 offen offset:1280
    buffer_load_dword v98, v41, s[4:7], 0 offen offset:2560
    buffer_load_dword v99, v40, s[4:7], 0 offen offset:0
    buffer_load_dword v100, v40, s[4:7], 0 offen offset:1280
    buffer_load_dword v101, v40, s[4:7], 0 offen offset:2560
    buffer_load_dword v102, v43, s[4:7], 0 offen offset:0
    buffer_load_dword v103, v43, s[4:7], 0 offen offset:1280
    buffer_load_dword v104, v43, s[4:7], 0 offen offset:2560
    buffer_load_dword v105, v40, s[8:11], 0 offen offset:0
    buffer_load_dword v106, v40, s[8:11], 0 offen offset:1280
    buffer_load_dword v107, v40, s[8:11], 0 offen offset:2560
    buffer_load_dword v108, v43, s[8:11], 0 offen offset:0
    buffer_load_dword v109, v43, s[8:11], 0 offen offset:1280
    buffer_load_dword v110, v43, s[8:11], 0 offen offset:2560
L_shadow:
    s_load_dword s60, s[16:17], 0
    s_load_dwordx2 s[56:57], s[0:1], 40
    s_load_dwordx2 s[52:53], s[0:1], 96
    s_load_dwordx2 s[48:49], s[0:1], 88
    s_load_dwordx2 s[28:29], s[0:1], 0
    s_load_dwordx2 s[32:33], s[0:1], 56
    v_and_b32 v1, 63, v0
    s_and_b32 s75, s2, 7
    s_mul_i32 s3, s75, 20
    s_add_u32 s3, s3, s74
    s_and_b32 s72, s74, 7
    s_lshl3_add_u32 s72, s75, s72
    s_and_b32 s73, s74, 8
    s_lshl3_add_u32 s59, s73, s72
    s_mov_b32 s22, 2621440
    s_mov_b32 s23, 0x20000
    s_cmp_ge_u32 s61, 5
    s_cselect_b32 s74, 1, 0
    s_mul_i32 s75, s74, 5
    s_sub_u32 s75, s61, s75
    s_mul_i32 s75, s75, 52
    v_add_u32 v12, s75, v1
    s_lshl2_add_u32 s75, s3, s74
    s_lshl_b32 s76, s75, 12
    s_sub_u32 s76, s76, 32
    v_lshl_add_u32 v46, v12, 4, s76
    v_subrev_u32 v43, 2, v12
    v_cmp_gt_u32 vcc, 256, v43
    s_and_b32 vcc_hi, vcc_hi, 0x1fffff
    s_cmp_lt_u32 s2, 160
    s_cselect_b64 vcc, vcc, 0
    v_mov_b32 v47, 0x7ffffff0
    v_cndmask_b32 v46, v47, v46, vcc
    s_movk_i32 s77, 0x2000
    s_mov_b32 s18, 16777216
    s_mov_b32 s19, 0x20000
    s_mov_b32 s30, 2621440
    s_mov_b32 s31, 0x20000
    s_mov_b32 s34, 1280
    s_mov_b32 s35, 0x20000
    s_mov_b32 s38, 2211840
    s_mov_b32 s39, 0x20000
    s_mov_b32 s42, 2211840
    s_mov_b32 s43, 0x20000
    s_mov_b32 s46, 2211840
    s_mov_b32 s47, 0x20000
    s_mov_b32 s50, 1280
    s_mov_b32 s51, 0x20000
    s_mov_b32 s54, 4915200
    s_mov_b32 s55, 0x20000
    s_mov_b32 s26, 2621440
    s_mov_b32 s27, 0x20000
    s_mov_b32 s63, 0xffff0000
    v_mov_b32 v29, 0xffff0000
    v_bfe_u32 v4, v0, 3, 3
    v_and_b32 v6, 0x70, v42
    v_and_b32 v5, 7, v0
    v_lshlrev_b32 v10, 7, v3
    v_lshlrev_b32 v11, 4, v1
    v_lshlrev_b32 v164, 2, v1
    s_lshl4_add_u32 s72, s2, s61
    s_cmpk_eq_u32 s72, 4064
    s_cbranch_scc1 L_locate
    s_mov_b32 s83, 22016
    v_mad_u32_u24 v9, v2, s83, v42
    s_mul_i32 s72, s71, 176128
    s_lshl_b32 s73, s70, 8
    s_add_u32 s72, s72, s73
    s_add_u32 s80, s72, 2097152
    s_add_u32 s81, s80, 88064
    s_mul_i32 s72, s61, 2560
    s_add_u32 s72, s72, 100224
    s_mov_b32 s83, 640
    v_mad_u32_u24 v7, v2, s83, v42
    v_add_u32 v7, s72, v7
    v_lshl_add_u32 v43, v2, 5, s72
    v_bfe_u32 v44, v0, 2, 2
    v_mad_u32_u24 v43, v44, s83, v43
    v_bfe_u32 v44, v0, 1, 1
    v_lshl_add_u32 v43, v44, 4, v43
    v_and_b32 v44, 1, v0
    s_mov_b32 s83, 320
    v_mad_u32_u24 v8, v44, s83, v43
    v_lshrrev_b32 v44, 1, v5
    v_lshlrev_b32 v43, 2, v0
    v_add_u32 v43, 157056, v43
    v_mov_b32 v45, 0
    ds_write_b32 v43, v45
    s_mul_i32 s72, s74, 16640
    v_lshl_add_u32 v13, v12, 4, s72
    s_sub_u32 s78, s61, 4
    s_cselect_b32 s72, 10, 0
    s_add_u32 s78, s78, s72
    s_mul_i32 s72, s78, 192
    s_sub_u32 s72, 66868, s72
    v_lshrrev_b32 v43, 2, v1
    v_mul_u32_u24 v43, 12, v43
    v_sub_u32 v43, s72, v43
    v_and_b32 v45, 3, v0
    s_mov_b32 s83, 4640
    v_mad_u32_u24 v14, v45, s83, v43
    v_and_b32 v45, 1, v0
    s_and_b32 s72, s61, 3
    s_mul_i32 s72, s72, 640
    s_add_u32 s72, s72, 100224
    v_lshl_add_u32 v43, v45, 2, s72
    v_lshl_add_u32 v43, v4, 3, v43
    s_mov_b32 s83, 160
    v_mad_u32_u24 v15, v44, s83, v43
    v_add_u32 v16, 64, v15
    s_mov_b32 s83, 20480
    v_mad_u32_u24 v17, v4, s83, v6
    s_cmp_ge_u32 s61, 4
    s_cbranch_scc1 L_nomf
    v_mov_b32 v64, 0
    v_mov_b32 v65, 0
    v_mov_b32 v66, 0
    v_mov_b32 v67, 0
    v_mov_b32 v68, 0
    v_mov_b32 v69, 0
    v_mov_b32 v70, 0
    v_mov_b32 v71, 0
    v_mov_b32 v72, 0
    v_mov_b32 v73, 0
    v_mov_b32 v74, 0
    v_mov_b32 v75, 0
    v_mov_b32 v76, 0
    v_mov_b32 v77, 0
    v_mov_b32 v78, 0
    v_mov_b32 v79, 0
    v_mov_b32 v80, 0
    v_mov_b32 v81, 0
    v_mov_b32 v82, 0
    v_mov_b32 v83, 0
    v_mov_b32 v84, 0
    v_mov_b32 v85, 0
    v_mov_b32 v86, 0
    v_mov_b32 v87, 0
    v_mov_b32 v88, 0
    v_mov_b32 v89, 0
    v_mov_b32 v90, 0
    v_mov_b32 v91, 0
    v_mov_b32 v92, 0
    v_mov_b32 v93, 0
    v_mov_b32 v94, 0
    v_mov_b32 v95, 0
    s_mul_i32 s72, s61, 4640
    s_add_u32 s76, s72, 70720
    v_min_u32 v43, 59, v1
    v_lshl_add_u32 v43, v43, 3, s76
    ds_write_b64 v43, v[64:65]
    s_add_u32 s72, s72, 67104
    v_lshl_add_u32 v161, v2, 4, s72
    v_lshlrev_b32 v43, 5, v3
    v_sub_u32 v161, v161, v43
    v_lshl_add_u32 v43, v2, 3, v3
    v_add_u32 v43, 1, v43
    v_and_b32 v45, 3, v43
    s_mul_i32 s72, s61, 16640
    v_lshl_add_u32 v43, v43, 1, s72
    s_mov_b32 s83, 4158
    v_mad_u32_u24 v160, v45, s83, v43
    s_mul_i32 s72, s61, 5120
    s_add_u32 s72, s72, 100224
    v_lshl_add_u32 v43, v3, 3, s72
    s_mov_b32 s83, 160
    v_mad_u32_u24 v162, v2, s83, v43
L_nomf:
    s_mov_b32 s83, 1280
    v_mad_u32_u24 v28, v4, s83, v6
    buffer_load_dwordx4 v[48:51], v46, s[20:23], 0 offen
    buffer_load_dwordx4 v[56:59], v46, s[20:23], s77 offen
    s_waitcnt lgkmcnt(0)
    s_load_dwordx2 s[40:41], s[0:1], 72
    s_load_dwordx2 s[44:45], s[0:1], 80
    s_load_dwordx2 s[24:25], s[0:1], 104
    s_load_dwordx2 s[36:37], s[0:1], 64
    s_min_u32 s72, s3, 159
    s_lshl_b32 s72, s72, 3
    s_load_dwordx2 s[68:69], s[56:57], s72
    s_mul_i32 s60, s60, 0x9e3779b1
    s_add_u32 s60, s60, 0x7f4a7c15
    s_and_b32 s60, s60, 0x1fffff
    s_or_b32 s60, s60, 0x7fa00000
    v_mov_b32 v167, s60
    s_cmpk_ge_u32 s58, 1720
    s_cbranch_scc1 L_notile
    s_setprio 1
    s_waitcnt vmcnt(17)
    v_lshlrev_b32 v116, 16, v112
    v_lshlrev_b32 v117, 16, v114
    v_and_b32 v118, v29, v112
    v_and_b32 v119, v29, v114
    v_lshlrev_b32 v120, 16, v113
    v_lshlrev_b32 v121, 16, v115
    v_and_b32 v122, v29, v113
    v_and_b32 v123, v29, v115
    s_waitcnt vmcnt(8)
    v_lshlrev_b32 v124, 16, v96
    v_and_b32 v125, v29, v96
    v_lshlrev_b32 v126, 16, v97
    v_and_b32 v127, v29, v97
    v_lshlrev_b32 v128, 16, v98
    v_and_b32 v129, v29, v98
    v_lshlrev_b32 v130, 16, v99
    v_and_b32 v131, v29, v99
    v_lshlrev_b32 v132, 16, v100
    v_and_b32 v133, v29, v100
    v_lshlrev_b32 v134, 16, v101
    v_and_b32 v135, v29, v101
    v_lshlrev_b32 v136, 16, v102
    v_and_b32 v137, v29, v102
    v_lshlrev_b32 v138, 16, v103
    v_and_b32 v139, v29, v103
    v_lshlrev_b32 v140, 16, v104
    v_and_b32 v141, v29, v104
    v_mov_b32 v99, v167
    v_mov_b32 v103, v167
    v_pk_mul_f32 v[142:143], v[116:117], v[130:131]
    v_pk_mul_f32 v[144:145], v[116:117], v[132:133]
    v_pk_mul_f32 v[146:147], v[116:117], v[134:135]
    v_pk_mul_f32 v[148:149], v[116:117], v[136:137]
    v_pk_mul_f32 v[150:151], v[116:117], v[138:139]
    v_pk_mul_f32 v[152:153], v[116:117], v[140:141]
    v_pk_fma_f32 v[142:143], v[118:119], v[128:129], v[142:143]
    v_pk_fma_f32 v[144:145], v[118:119], v[130:131], v[144:145]
    v_pk_fma_f32 v[146:147], v[118:119], v[132:133], v[146:147]
    v_pk_fma_f32 v[148:149], v[118:119], v[134:135], v[148:149]
    v_pk_fma_f32 v[150:151], v[118:119], v[136:137], v[150:151]
    v_pk_fma_f32 v[152:153], v[118:119], v[138:139], v[152:153]
    v_pk_fma_f32 v[142:143], v[120:121], v[126:127], v[142:143]
    v_pk_fma_f32 v[144:145], v[120:121], v[128:129], v[144:145]
    v_pk_fma_f32 v[146:147], v[120:121], v[130:131], v[146:147]
    v_pk_fma_f32 v[148:149], v[120:121], v[132:133], v[148:149]
    v_pk_fma_f32 v[150:151], v[120:121], v[134:135], v[150:151]
    v_pk_fma_f32 v[152:153], v[120:121], v[136:137], v[152:153]
    v_pk_fma_f32 v[142:143], v[122:123], v[124:125], v[142:143]
    v_pk_fma_f32 v[144:145], v[122:123], v[126:127], v[144:145]
    v_pk_fma_f32 v[146:147], v[122:123], v[128:129], v[146:147]
    v_pk_fma_f32 v[148:149], v[122:123], v[130:131], v[148:149]
    v_pk_fma_f32 v[150:151], v[122:123], v[132:133], v[150:151]
    v_pk_fma_f32 v[152:153], v[122:123], v[134:135], v[152:153]
    s_waitcnt vmcnt(2)
    v_lshlrev_b32 v124, 16, v105
    v_and_b32 v125, v29, v105
    v_lshlrev_b32 v126, 16, v106
    v_and_b32 v127, v29, v106
    v_lshlrev_b32 v128, 16, v107
    v_and_b32 v129, v29, v107
    v_lshlrev_b32 v130, 16, v108
    v_and_b32 v131, v29, v108
    v_lshlrev_b32 v132, 16, v109
    v_and_b32 v133, v29, v109
    v_lshlrev_b32 v134, 16, v110
    v_and_b32 v135, v29, v110
    v_pk_mul_f32 v[142:143], v[142:143], v[124:125]
    v_pk_mul_f32 v[144:145], v[144:145], v[126:127]
    v_pk_mul_f32 v[146:147], v[146:147], v[128:129]
    v_pk_mul_f32 v[148:149], v[148:149], v[130:131]
    v_pk_mul_f32 v[150:151], v[150:151], v[132:133]
    v_pk_mul_f32 v[152:153], v[152:153], v[134:135]
    v_cvt_pk_bf16_f32 v96, v152, v150
    v_cvt_pk_bf16_f32 v97, v148, v146
    v_cvt_pk_bf16_f32 v98, v144, v142
    ds_write_b128 v7, v[96:99] offset:0
    v_cvt_pk_bf16_f32 v100, v153, v151
    v_cvt_pk_bf16_f32 v101, v149, v147
    v_cvt_pk_bf16_f32 v102, v145, v143
    ds_write_b128 v7, v[100:103] offset:320
    ds_read_b128 v[104:107], v8
    ds_read_b128 v[108:111], v8 offset:128
    s_waitcnt lgkmcnt(0)
    buffer_store_dwordx4 v[104:107], v9, s[16:19], s80 offen sc1
    buffer_store_dwordx4 v[108:111], v9, s[16:19], s81 offen sc1
    s_setprio 0
    s_waitcnt vmcnt(2)
    s_branch L_tiled
L_notile:
    s_cmp_ge_u32 s2, 160
    s_waitcnt lgkmcnt(0)
    s_cbranch_scc1 L_nonconv
    s_waitcnt vmcnt(0)
L_tiled:
    s_cmp_ge_u32 s2, 160
    s_cbranch_scc1 L_nonconv
    s_mul_i32 s72, s3, 22016
    s_lshl_b32 s73, s78, 10
    s_add_u32 s72, s72, s73
    s_add_u32 s80, s72, 2097152
    s_add_u32 s82, s80, 20480
    s_add_u32 s80, s80, s73
    s_bfe_u32 s73, s3, 0x10005
    s_lshl_b32 s72, s73, 8
    s_add_u32 s80, s80, s72
    s_xor_b32 s81, s80, 256
    v_lshl_add_u32 v62, v2, 8, v11
    s_mul_i32 s72, s78, 192
    s_sub_u32 s72, 3840, s72
    v_mul_u32_u24 v41, 48, v2
    v_sub_u32 v41, v14, v41
    s_mul_i32 s73, s73, 48
    s_sub_u32 s83, s72, s73
    v_add_u32 v42, s83, v41
    s_add_u32 s72, s72, s73
    s_sub_u32 s72, s72, 48
    v_add_u32 v41, s72, v41
    s_mov_b64 s[70:71], -1
    s_mov_b64 s[76:77], -1
    s_cmp_eq_u32 s78, 1
    s_cselect_b32 s74, 0xffffff, 0
    s_mov_b32 s75, 0
    s_cmp_eq_u32 s78, 0
    s_cselect_b64 s[74:75], -1, s[74:75]
    s_mov_b64 s[66:67], s[74:75]
    v_mov_b32 v47, v167
    v_cmp_eq_u32 s[64:65], 2, v12
    s_cmp_eq_u64 s[64:65], 0
    s_cbranch_scc1 L_nofold0
    s_lshl_b32 s72, s68, 16
    s_and_b32 s73, s68, s63
    s_cmp_ge_u32 s61, 5
    s_cselect_b32 s72, s73, s72
    v_lshlrev_b32 v40, 16, v48
    v_add_f32 v40, s72, v40
    v_cvt_pk_bf16_f32 v40, v40, v40
    v_bfi_b32 v40, s63, v48, v40
    v_cndmask_b32 v48, v48, v40, s[64:65]
L_nofold0:
    v_mov_b32_dpp v53, v49 wave_shl:1 row_mask:0xf bank_mask:0xf
    s_nop 0
    v_mov_b32_dpp v52, v48 wave_shl:1 row_mask:0xf bank_mask:0xf
    v_alignbit_b32 v120, v49, v48, 16
    v_mov_b32 v124, v49
    v_alignbit_b32 v128, v50, v49, 16
    v_alignbit_b32 v121, v50, v49, 16
    v_mov_b32 v125, v50
    v_alignbit_b32 v129, v51, v50, 16
    v_alignbit_b32 v122, v51, v50, 16
    v_mov_b32 v126, v51
    v_alignbit_b32 v130, v52, v51, 16
    v_alignbit_b32 v123, v52, v51, 16
    v_mov_b32 v127, v52
    v_alignbit_b32 v131, v53, v52, 16
    s_mov_b32 exec_hi, 0xfffff
    ds_write_b128 v13, v[48:51] offset:0
    ds_write_b128 v13, v[120:123] offset:4160
    ds_write_b128 v13, v[124:127] offset:8320
    ds_write_b128 v13, v[128:131] offset:12480
    s_mov_b32 exec_hi, -1
    s_cmp_eq_u64 s[64:65], 0
    s_cbranch_scc1 L_nofold1
    s_lshl_b32 s72, s69, 16
    s_and_b32 s73, s69, s63
    s_cmp_ge_u32 s61, 5
    s_cselect_b32 s72, s73, s72
    v_lshlrev_b32 v40, 16, v56
    v_add_f32 v40, s72, v40
    v_cvt_pk_bf16_f32 v40, v40, v40
    v_bfi_b32 v40, s63, v56, v40
    v_cndmask_b32 v56, v56, v40, s[64:65]
L_nofold1:
    v_mov_b32_dpp v61, v57 wave_shl:1 row_mask:0xf bank_mask:0xf
    s_nop 0
    v_mov_b32_dpp v60, v56 wave_shl:1 row_mask:0xf bank_mask:0xf
    v_alignbit_b32 v132, v57, v56, 16
    v_mov_b32 v136, v57
    v_alignbit_b32 v140, v58, v57, 16
    v_alignbit_b32 v133, v58, v57, 16
    v_mov_b32 v137, v58
    v_alignbit_b32 v141, v59, v58, 16
    v_alignbit_b32 v134, v59, v58, 16
    v_mov_b32 v138, v59
    v_alignbit_b32 v142, v60, v59, 16
    v_alignbit_b32 v135, v60, v59, 16
    v_mov_b32 v139, v60
    v_alignbit_b32 v143, v61, v60, 16
    s_mov_b32 exec_hi, 0xfffff
    ds_write_b128 v13, v[56:59] offset:33280
    ds_write_b128 v13, v[132:135] offset:37440
    ds_write_b128 v13, v[136:139] offset:41600
    ds_write_b128 v13, v[140:143] offset:45760
    s_mov_b32 exec_hi, -1
    s_lshl_b32 s72, s61, 7
    s_add_u32 s72, s72, 120704
    v_lshl_add_u32 v43, v4, 4, s72
    s_mov_b32 s83, 2624
    v_mad_u32_u24 v18, v5, s83, v43
    v_add_u32 v43, s72, v6
    s_mov_b32 s83, 1312
    v_mad_u32_u24 v27, v4, s83, v43
    v_add_u32 v19, 159616, v6
    s_lshl_b32 s72, s61, 8
    s_add_u32 s73, s72, 141696
    v_lshl_add_u32 v20, v4, 5, s73
    s_add_u32 s73, s72, 85248
    v_lshl_add_u32 v25, v4, 5, s73
    v_lshl_add_u32 v26, v1, 3, s73
    s_mov_b32 s83, 44032
    v_mad_u32_u24 v21, v4, s83, v6
    v_mul_u32_u24 v43, 48, v5
    v_add_u32 v23, 157056, v43
    v_bfe_u32 v43, v0, 4, 1
    v_bfe_u32 v45, v0, 3, 1
    v_lshl_add_u32 v43, v45, 1, v43
    v_min_u32 v43, 2, v43
    v_lshl_add_u32 v43, v43, 4, v23
    v_bfe_u32 v45, v0, 5, 1
    v_lshl_add_u32 v22, v45, 3, v43
    s_lshl_b32 s72, s59, 4
    v_lshl_add_u32 v24, v5, 1, s72
    v_xor_b32 v24, 0x7ff, v24
    v_bfe_u32 v43, v0, 3, 1
    v_lshlrev_b32 v43, 13, v43
    v_lshl_add_u32 v7, v5, 16, v43
    v_add_u32 v10, v6, v43
    v_subrev_u32 v8, 1, v24
    v_mov_b32 v158, 0x4083126f
    v_lshlrev_b32 v9, 4, v4
    v_sub_u32 v9, v25, v9
    s_lshl_b32 s72, s61, 8
    s_add_u32 s72, s72, 85248
    v_add_u32 v12, s72, v6
    v_mov_b32 v13, 157440
    s_waitcnt lgkmcnt(0)
    buffer_load_dwordx4 v[32:35], v62, s[16:19], s80 offen sc1
    s_barrier
    s_mov_b64 exec, s[76:77]
    buffer_load_dwordx4 v[36:39], v62, s[16:19], s81 offen sc1
    s_and_b64 exec, s[66:67], s[66:67]
    s_cbranch_scc0 L_no3_1
    buffer_load_dwordx4 v[44:47], v11, s[16:19], s82 offen sc1
L_no3_1:
    s_mov_b64 exec, -1
    s_cmp_ge_u32 s61, 4
    s_cbranch_scc1 L_noA
    ds_read_b64 v[96:97], v160 offset:3584
    ds_read_b64 v[98:99], v160 offset:3592
    ds_read_b64 v[100:101], v160 offset:3072
    ds_read_b64 v[102:103], v160 offset:3080
    ds_read_b64 v[104:105], v160 offset:2560
    ds_read_b64 v[106:107], v160 offset:2568
    ds_read_b64 v[108:109], v160 offset:2048
    ds_read_b64 v[110:111], v160 offset:2056
    ds_read_b64 v[112:113], v160 offset:1536
    ds_read_b64 v[114:115], v160 offset:1544
    ds_read_b64 v[116:117], v160 offset:1024
    ds_read_b64 v[118:119], v160 offset:1032
    ds_read_b64 v[120:121], v160 offset:512
    ds_read_b64 v[122:123], v160 offset:520
L_noA:
    v_mov_b32 v30, 158880
    v_mov_b32 v31, 1
    s_mov_b32 s79, 0
L_kv_2:
    s_waitcnt vmcnt(1)
    ds_write2_b32 v42, v32, v33 offset0:0 offset1:1
    ds_write_b32 v42, v34 offset:8
    s_waitcnt vmcnt(0)
    v_cmp_ne_u32 s[70:71], v167, v35
    v_cmp_ne_u32 s[76:77], v167, v39
    v_cmp_ne_u32 s[66:67], v167, v47
    s_or_b64 vcc, s[70:71], s[76:77]
    s_or_b64 vcc, vcc, s[66:67]
    s_cbranch_scc0 L_kv_done_3
    s_and_b64 exec, s[70:71], s[70:71]
    s_cbranch_scc0 L_held_4
    buffer_load_dwordx4 v[32:35], v62, s[16:19], s80 offen sc1
L_held_4:
    s_and_b64 exec, s[76:77], s[76:77]
    s_cbranch_scc0 L_held_5
    buffer_load_dwordx4 v[36:39], v62, s[16:19], s81 offen sc1
L_held_5:
    s_and_b64 exec, s[66:67], s[66:67]
    s_cbranch_scc0 L_held_6
    buffer_load_dwordx4 v[44:47], v11, s[16:19], s82 offen sc1
L_held_6:
    s_mov_b64 exec, -1
    s_add_u32 s79, s79, 1
    s_cmp_gt_u32 s79, 524288
    s_waitcnt vmcnt(0)
    s_cbranch_scc0 L_kv_2
L_kv_done_3:
    ds_write2_b32 v41, v36, v37 offset0:0 offset1:1
    ds_write_b32 v41, v38 offset:8
    s_and_b64 exec, s[74:75], s[74:75]
    s_cbranch_scc0 L_now3
    ds_write2_b32 v14, v44, v45 offset0:0 offset1:1
    ds_write_b32 v14, v46 offset:8
L_now3:
    s_mov_b64 exec, -1
    s_and_b32 s75, s61, 3
    s_mul_i32 s72, s3, 22016
    s_lshl_b32 s73, s75, 11
    s_add_u32 s72, s72, s73
    s_add_u32 s80, s72, 2097152
    s_add_u32 s81, s80, 8192
    s_cmp_ge_u32 s61, 4
    s_waitcnt lgkmcnt(0)
    s_barrier
    s_cbranch_scc1 L_helper
    s_setprio 3
    ds_read_b128 v[124:127], v161 offset:3584
    ds_read_b128 v[128:131], v161 offset:3072
    ds_read_b128 v[132:135], v161 offset:2560
    ds_read_b128 v[136:139], v161 offset:2048
    s_waitcnt lgkmcnt(3)
    v_mfma_f32_16x16x32_bf16 v[92:95], v[96:99], v[124:127], v[92:95]
    ds_read_b64 v[140:141], v160 offset:0
    ds_read_b64 v[142:143], v160 offset:8
    s_waitcnt lgkmcnt(4)
    v_mfma_f32_16x16x32_bf16 v[92:95], v[100:103], v[128:131], v[92:95]
    ds_read_b128 v[144:147], v161 offset:1536
    s_waitcnt lgkmcnt(4)
    v_mfma_f32_16x16x32_bf16 v[92:95], v[104:107], v[132:135], v[92:95]
    ds_read_b128 v[148:151], v161 offset:1024
    s_waitcnt lgkmcnt(4)
    v_mfma_f32_16x16x32_bf16 v[92:95], v[108:111], v[136:139], v[92:95]
    ds_read_b128 v[152:155], v161 offset:512
    v_mfma_f32_16x16x32_bf16 v[88:91], v[100:103], v[124:127], v[88:91]
    ds_read_b128 v[156:159], v161 offset:0
    v_mfma_f32_16x16x32_bf16 v[88:91], v[104:107], v[128:131], v[88:91]
    ds_read_b128 v[96:99], v161 offset:3648
    v_mfma_f32_16x16x32_bf16 v[88:91], v[108:111], v[132:135], v[88:91]
    ds_read_b64 v[100:101], v160 offset:3648
    v_mfma_f32_16x16x32_bf16 v[84:87], v[104:107], v[124:127], v[84:87]
    ds_read_b64 v[102:103], v160 offset:3656
    v_mfma_f32_16x16x32_bf16 v[84:87], v[108:111], v[128:131], v[84:87]
    ds_read_b128 v[104:107], v161 offset:3136
    v_mfma_f32_16x16x32_bf16 v[80:83], v[108:111], v[124:127], v[80:83]
    ds_read_b64 v[108:109], v160 offset:3136
    s_waitcnt lgkmcnt(6)
    v_mfma_f32_16x16x32_bf16 v[64:67], v[140:143], v[124:127], v[64:67]
    ds_read_b64 v[110:111], v160 offset:3144
    v_mfma_f32_16x16x32_bf16 v[68:71], v[120:123], v[124:127], v[68:71]
    v_mfma_f32_16x16x32_bf16 v[68:71], v[140:143], v[128:131], v[68:71]
    v_mfma_f32_16x16x32_bf16 v[72:75], v[116:119], v[124:127], v[72:75]
    v_mfma_f32_16x16x32_bf16 v[72:75], v[120:123], v[128:131], v[72:75]
    v_mfma_f32_16x16x32_bf16 v[72:75], v[140:143], v[132:135], v[72:75]
    v_mfma_f32_16x16x32_bf16 v[76:79], v[112:115], v[124:127], v[76:79]
    ds_read_b128 v[124:127], v161 offset:2624
    v_mfma_f32_16x16x32_bf16 v[76:79], v[116:119], v[128:131], v[76:79]
    v_mfma_f32_16x16x32_bf16 v[76:79], v[120:123], v[132:135], v[76:79]
    v_mfma_f32_16x16x32_bf16 v[76:79], v[140:143], v[136:139], v[76:79]
    v_mfma_f32_16x16x32_bf16 v[88:91], v[112:115], v[136:139], v[88:91]
    v_mfma_f32_16x16x32_bf16 v[84:87], v[112:115], v[132:135], v[84:87]
    v_mfma_f32_16x16x32_bf16 v[84:87], v[116:119], v[136:139], v[84:87]
    v_mfma_f32_16x16x32_bf16 v[80:83], v[112:115], v[128:131], v[80:83]
    ds_read_b64 v[128:129], v160 offset:2624
    v_mfma_f32_16x16x32_bf16 v[80:83], v[116:119], v[132:135], v[80:83]
    ds_read_b64 v[130:131], v160 offset:2632
    v_mfma_f32_16x16x32_bf16 v[80:83], v[120:123], v[136:139], v[80:83]
    ds_read_b128 v[132:135], v161 offset:2112
    v_mfma_f32_16x16x32_bf16 v[80:83], v[140:143], v[144:147], v[80:83]
    ds_read_b64 v[136:137], v160 offset:2112
    v_mfma_f32_16x16x32_bf16 v[84:87], v[120:123], v[144:147], v[84:87]
    ds_read_b64 v[138:139], v160 offset:2120
    v_mfma_f32_16x16x32_bf16 v[84:87], v[140:143], v[148:151], v[84:87]
    v_mfma_f32_16x16x32_bf16 v[88:91], v[116:119], v[144:147], v[88:91]
    v_mfma_f32_16x16x32_bf16 v[88:91], v[120:123], v[148:151], v[88:91]
    v_mfma_f32_16x16x32_bf16 v[88:91], v[140:143], v[152:155], v[88:91]
    v_mfma_f32_16x16x32_bf16 v[92:95], v[112:115], v[144:147], v[92:95]
    ds_read_b64 v[112:113], v160 offset:64
    v_mfma_f32_16x16x32_bf16 v[92:95], v[116:119], v[148:151], v[92:95]
    ds_read_b64 v[114:115], v160 offset:72
    v_mfma_f32_16x16x32_bf16 v[92:95], v[120:123], v[152:155], v[92:95]
    ds_read_b64 v[144:145], v160 offset:576
    s_waitcnt lgkmcnt(3)
    v_mfma_f32_16x16x32_bf16 v[92:95], v[140:143], v[156:159], v[92:95]
    ds_read_b64 v[146:147], v160 offset:584
    v_mfma_f32_16x16x32_bf16 v[92:95], v[100:103], v[96:99], v[92:95]
    ds_read_b64 v[116:117], v160 offset:1088
    v_mfma_f32_16x16x32_bf16 v[92:95], v[108:111], v[104:107], v[92:95]
    ds_read_b64 v[118:119], v160 offset:1096
    v_mfma_f32_16x16x32_bf16 v[92:95], v[128:131], v[124:127], v[92:95]
    ds_read_b64 v[148:149], v160 offset:1600
    v_mfma_f32_16x16x32_bf16 v[92:95], v[136:139], v[132:135], v[92:95]
    ds_read_b64 v[150:151], v160 offset:1608
    v_mfma_f32_16x16x32_bf16 v[88:91], v[108:111], v[96:99], v[88:91]
    ds_read_b128 v[120:123], v161 offset:1600
    v_mfma_f32_16x16x32_bf16 v[88:91], v[128:131], v[104:107], v[88:91]
    ds_read_b128 v[152:155], v161 offset:1088
    v_mfma_f32_16x16x32_bf16 v[88:91], v[136:139], v[124:127], v[88:91]
    ds_read_b128 v[140:143], v161 offset:576
    v_mfma_f32_16x16x32_bf16 v[84:87], v[128:131], v[96:99], v[84:87]
    ds_read_b128 v[156:159], v161 offset:64
    v_mfma_f32_16x16x32_bf16 v[84:87], v[136:139], v[104:107], v[84:87]
    ds_read_b128 v[100:103], v161 offset:3712
    v_mfma_f32_16x16x32_bf16 v[80:83], v[136:139], v[96:99], v[80:83]
    ds_read_b64 v[108:109], v160 offset:3712
    s_waitcnt lgkmcnt(6)
    v_mfma_f32_16x16x32_bf16 v[64:67], v[112:115], v[96:99], v[64:67]
    ds_read_b64 v[110:111], v160 offset:3720
    v_mfma_f32_16x16x32_bf16 v[68:71], v[144:147], v[96:99], v[68:71]
    ds_read_b128 v[128:131], v161 offset:3200
    v_mfma_f32_16x16x32_bf16 v[68:71], v[112:115], v[104:107], v[68:71]
    ds_read_b64 v[136:137], v160 offset:3200
    v_mfma_f32_16x16x32_bf16 v[72:75], v[116:119], v[96:99], v[72:75]
    ds_read_b64 v[138:139], v160 offset:3208
    v_mfma_f32_16x16x32_bf16 v[72:75], v[144:147], v[104:107], v[72:75]
    v_mfma_f32_16x16x32_bf16 v[72:75], v[112:115], v[124:127], v[72:75]
    v_mfma_f32_16x16x32_bf16 v[76:79], v[148:151], v[96:99], v[76:79]
    ds_read_b128 v[96:99], v161 offset:2688
    v_mfma_f32_16x16x32_bf16 v[76:79], v[116:119], v[104:107], v[76:79]
    v_mfma_f32_16x16x32_bf16 v[76:79], v[144:147], v[124:127], v[76:79]
    v_mfma_f32_16x16x32_bf16 v[76:79], v[112:115], v[132:135], v[76:79]
    v_mfma_f32_16x16x32_bf16 v[88:91], v[148:151], v[132:135], v[88:91]
    v_mfma_f32_16x16x32_bf16 v[84:87], v[148:151], v[124:127], v[84:87]
    v_mfma_f32_16x16x32_bf16 v[84:87], v[116:119], v[132:135], v[84:87]
    v_mfma_f32_16x16x32_bf16 v[80:83], v[148:151], v[104:107], v[80:83]
    ds_read_b64 v[104:105], v160 offset:2688
    v_mfma_f32_16x16x32_bf16 v[80:83], v[116:119], v[124:127], v[80:83]
    ds_read_b64 v[106:107], v160 offset:2696
    v_mfma_f32_16x16x32_bf16 v[80:83], v[144:147], v[132:135], v[80:83]
    ds_read_b128 v[124:127], v161 offset:2176
    s_waitcnt lgkmcnt(3)
    v_mfma_f32_16x16x32_bf16 v[80:83], v[112:115], v[120:123], v[80:83]
    ds_read_b64 v[132:133], v160 offset:2176
    v_mfma_f32_16x16x32_bf16 v[84:87], v[144:147], v[120:123], v[84:87]
    ds_read_b64 v[134:135], v160 offset:2184
    v_mfma_f32_16x16x32_bf16 v[84:87], v[112:115], v[152:155], v[84:87]
    v_mfma_f32_16x16x32_bf16 v[88:91], v[116:119], v[120:123], v[88:91]
    v_mfma_f32_16x16x32_bf16 v[88:91], v[144:147], v[152:155], v[88:91]
    v_mfma_f32_16x16x32_bf16 v[88:91], v[112:115], v[140:143], v[88:91]
    v_mfma_f32_16x16x32_bf16 v[92:95], v[148:151], v[120:123], v[92:95]
    ds_read_b64 v[148:149], v160 offset:128
    v_mfma_f32_16x16x32_bf16 v[92:95], v[116:119], v[152:155], v[92:95]
    ds_read_b64 v[150:151], v160 offset:136
    v_mfma_f32_16x16x32_bf16 v[92:95], v[144:147], v[140:143], v[92:95]
    ds_read_b64 v[120:121], v160 offset:640
    v_mfma_f32_16x16x32_bf16 v[92:95], v[112:115], v[156:159], v[92:95]
    ds_read_b64 v[122:123], v160 offset:648
    v_mfma_f32_16x16x32_bf16 v[92:95], v[108:111], v[100:103], v[92:95]
    ds_read_b64 v[116:117], v160 offset:1152
    v_mfma_f32_16x16x32_bf16 v[92:95], v[136:139], v[128:131], v[92:95]
    ds_read_b64 v[118:119], v160 offset:1160
    s_waitcnt lgkmcnt(6)
    v_mfma_f32_16x16x32_bf16 v[92:95], v[104:107], v[96:99], v[92:95]
    ds_read_b64 v[152:153], v160 offset:1664
    v_mfma_f32_16x16x32_bf16 v[92:95], v[132:135], v[124:127], v[92:95]
    ds_read_b64 v[154:155], v160 offset:1672
    v_mfma_f32_16x16x32_bf16 v[88:91], v[136:139], v[100:103], v[88:91]
    ds_read_b128 v[144:147], v161 offset:1664
    v_mfma_f32_16x16x32_bf16 v[88:91], v[104:107], v[128:131], v[88:91]
    ds_read_b128 v[140:143], v161 offset:1152
    v_mfma_f32_16x16x32_bf16 v[88:91], v[132:135], v[96:99], v[88:91]
    ds_read_b128 v[112:115], v161 offset:640
    v_mfma_f32_16x16x32_bf16 v[84:87], v[104:107], v[100:103], v[84:87]
    ds_read_b128 v[156:159], v161 offset:128
    v_mfma_f32_16x16x32_bf16 v[84:87], v[132:135], v[128:131], v[84:87]
    ds_read_b128 v[108:111], v161 offset:3776
    v_mfma_f32_16x16x32_bf16 v[80:83], v[132:135], v[100:103], v[80:83]
    ds_read_b64 v[136:137], v160 offset:3776
    s_waitcnt lgkmcnt(6)
    v_mfma_f32_16x16x32_bf16 v[64:67], v[148:151], v[100:103], v[64:67]
    ds_read_b64 v[138:139], v160 offset:3784
    v_mfma_f32_16x16x32_bf16 v[68:71], v[120:123], v[100:103], v[68:71]
    ds_read_b128 v[104:107], v161 offset:3264
    v_mfma_f32_16x16x32_bf16 v[68:71], v[148:151], v[128:131], v[68:71]
    ds_read_b64 v[132:133], v160 offset:3264
    v_mfma_f32_16x16x32_bf16 v[72:75], v[116:119], v[100:103], v[72:75]
    ds_read_b64 v[134:135], v160 offset:3272
    v_mfma_f32_16x16x32_bf16 v[72:75], v[120:123], v[128:131], v[72:75]
    v_mfma_f32_16x16x32_bf16 v[72:75], v[148:151], v[96:99], v[72:75]
    v_mfma_f32_16x16x32_bf16 v[76:79], v[152:155], v[100:103], v[76:79]
    ds_read_b128 v[100:103], v161 offset:2752
    v_mfma_f32_16x16x32_bf16 v[76:79], v[116:119], v[128:131], v[76:79]
    v_mfma_f32_16x16x32_bf16 v[76:79], v[120:123], v[96:99], v[76:79]
    v_mfma_f32_16x16x32_bf16 v[76:79], v[148:151], v[124:127], v[76:79]
    v_mfma_f32_16x16x32_bf16 v[88:91], v[152:155], v[124:127], v[88:91]
    v_mfma_f32_16x16x32_bf16 v[84:87], v[152:155], v[96:99], v[84:87]
    v_mfma_f32_16x16x32_bf16 v[84:87], v[116:119], v[124:127], v[84:87]
    v_mfma_f32_16x16x32_bf16 v[80:83], v[152:155], v[128:131], v[80:83]
    ds_read_b64 v[128:129], v160 offset:2752
    v_mfma_f32_16x16x32_bf16 v[80:83], v[116:119], v[96:99], v[80:83]
    ds_read_b64 v[130:131], v160 offset:2760
    v_mfma_f32_16x16x32_bf16 v[80:83], v[120:123], v[124:127], v[80:83]
    ds_read_b128 v[96:99], v161 offset:2240
    s_waitcnt lgkmcnt(3)
    v_mfma_f32_16x16x32_bf16 v[80:83], v[148:151], v[144:147], v[80:83]
    ds_read_b64 v[124:125], v160 offset:2240
    v_mfma_f32_16x16x32_bf16 v[84:87], v[120:123], v[144:147], v[84:87]
    ds_read_b64 v[126:127], v160 offset:2248
    v_mfma_f32_16x16x32_bf16 v[84:87], v[148:151], v[140:143], v[84:87]
    v_mfma_f32_16x16x32_bf16 v[88:91], v[116:119], v[144:147], v[88:91]
    v_mfma_f32_16x16x32_bf16 v[88:91], v[120:123], v[140:143], v[88:91]
    v_mfma_f32_16x16x32_bf16 v[88:91], v[148:151], v[112:115], v[88:91]
    v_mfma_f32_16x16x32_bf16 v[92:95], v[152:155], v[144:147], v[92:95]
    ds_read_b64 v[152:153], v160 offset:192
    v_mfma_f32_16x16x32_bf16 v[92:95], v[116:119], v[140:143], v[92:95]
    ds_read_b64 v[154:155], v160 offset:200
    v_mfma_f32_16x16x32_bf16 v[92:95], v[120:123], v[112:115], v[92:95]
    ds_read_b64 v[144:145], v160 offset:704
    v_mfma_f32_16x16x32_bf16 v[92:95], v[148:151], v[156:159], v[92:95]
    ds_read_b64 v[146:147], v160 offset:712
    v_mfma_f32_16x16x32_bf16 v[92:95], v[136:139], v[108:111], v[92:95]
    ds_read_b64 v[116:117], v160 offset:1216
    v_mfma_f32_16x16x32_bf16 v[92:95], v[132:135], v[104:107], v[92:95]
    ds_read_b64 v[118:119], v160 offset:1224
    s_waitcnt lgkmcnt(6)
    v_mfma_f32_16x16x32_bf16 v[92:95], v[128:131], v[100:103], v[92:95]
    ds_read_b64 v[140:141], v160 offset:1728
    v_mfma_f32_16x16x32_bf16 v[92:95], v[124:127], v[96:99], v[92:95]
    ds_read_b64 v[142:143], v160 offset:1736
    v_mfma_f32_16x16x32_bf16 v[88:91], v[132:135], v[108:111], v[88:91]
    ds_read_b128 v[120:123], v161 offset:1728
    v_mfma_f32_16x16x32_bf16 v[88:91], v[128:131], v[104:107], v[88:91]
    ds_read_b128 v[112:115], v161 offset:1216
    v_mfma_f32_16x16x32_bf16 v[88:91], v[124:127], v[100:103], v[88:91]
    ds_read_b128 v[148:151], v161 offset:704
    v_mfma_f32_16x16x32_bf16 v[84:87], v[128:131], v[108:111], v[84:87]
    ds_read_b128 v[156:159], v161 offset:192
    v_mfma_f32_16x16x32_bf16 v[84:87], v[124:127], v[104:107], v[84:87]
    ds_read_b128 v[136:139], v161 offset:4032
    v_mfma_f32_16x16x32_bf16 v[80:83], v[124:127], v[108:111], v[80:83]
    ds_read_b64 v[132:133], v160 offset:448
    s_waitcnt lgkmcnt(6)
    v_mfma_f32_16x16x32_bf16 v[64:67], v[152:155], v[108:111], v[64:67]
    ds_read_b64 v[134:135], v160 offset:456
    v_mfma_f32_16x16x32_bf16 v[68:71], v[144:147], v[108:111], v[68:71]
    ds_read_b64 v[128:129], v160 offset:960
    v_mfma_f32_16x16x32_bf16 v[68:71], v[152:155], v[104:107], v[68:71]
    ds_read_b64 v[130:131], v160 offset:968
    v_mfma_f32_16x16x32_bf16 v[72:75], v[116:119], v[108:111], v[72:75]
    ds_read_b128 v[124:127], v161 offset:3520
    v_mfma_f32_16x16x32_bf16 v[72:75], v[144:147], v[104:107], v[72:75]
    v_mfma_f32_16x16x32_bf16 v[72:75], v[152:155], v[100:103], v[72:75]
    v_mfma_f32_16x16x32_bf16 v[76:79], v[140:143], v[108:111], v[76:79]
    ds_read_b64 v[108:109], v160 offset:1472
    v_mfma_f32_16x16x32_bf16 v[76:79], v[116:119], v[104:107], v[76:79]
    ds_read_b64 v[110:111], v160 offset:1480
    v_mfma_f32_16x16x32_bf16 v[76:79], v[144:147], v[100:103], v[76:79]
    v_mfma_f32_16x16x32_bf16 v[76:79], v[152:155], v[96:99], v[76:79]
    v_mfma_f32_16x16x32_bf16 v[88:91], v[140:143], v[96:99], v[88:91]
    v_mfma_f32_16x16x32_bf16 v[84:87], v[140:143], v[100:103], v[84:87]
    v_mfma_f32_16x16x32_bf16 v[84:87], v[116:119], v[96:99], v[84:87]
    v_mfma_f32_16x16x32_bf16 v[80:83], v[140:143], v[104:107], v[80:83]
    ds_read_b128 v[104:107], v161 offset:3008
    v_mfma_f32_16x16x32_bf16 v[80:83], v[116:119], v[100:103], v[80:83]
    ds_read_b64 v[100:101], v160 offset:1984
    v_mfma_f32_16x16x32_bf16 v[80:83], v[144:147], v[96:99], v[80:83]
    ds_read_b64 v[102:103], v160 offset:1992
    s_waitcnt lgkmcnt(3)
    v_mfma_f32_16x16x32_bf16 v[80:83], v[152:155], v[120:123], v[80:83]
    ds_read_b128 v[96:99], v161 offset:2496
    v_mfma_f32_16x16x32_bf16 v[84:87], v[144:147], v[120:123], v[84:87]
    v_mfma_f32_16x16x32_bf16 v[84:87], v[152:155], v[112:115], v[84:87]
    v_mfma_f32_16x16x32_bf16 v[88:91], v[116:119], v[120:123], v[88:91]
    v_mfma_f32_16x16x32_bf16 v[88:91], v[144:147], v[112:115], v[88:91]
    v_mfma_f32_16x16x32_bf16 v[88:91], v[152:155], v[148:151], v[88:91]
    v_mfma_f32_16x16x32_bf16 v[92:95], v[140:143], v[120:123], v[92:95]
    ds_read_b128 v[140:143], v161 offset:3968
    v_mfma_f32_16x16x32_bf16 v[92:95], v[116:119], v[112:115], v[92:95]
    ds_read_b64 v[120:121], v160 offset:384
    v_mfma_f32_16x16x32_bf16 v[92:95], v[144:147], v[148:151], v[92:95]
    ds_read_b64 v[122:123], v160 offset:392
    v_mfma_f32_16x16x32_bf16 v[92:95], v[152:155], v[156:159], v[92:95]
    ds_read_b64 v[116:117], v160 offset:896
    v_mfma_f32_16x16x32_bf16 v[64:67], v[132:135], v[136:139], v[64:67]
    ds_read_b64 v[118:119], v160 offset:904
    ds_read_b128 v[112:115], v161 offset:3456
    v_mfma_f32_16x16x32_bf16 v[68:71], v[128:131], v[136:139], v[68:71]
    ds_read_b64 v[144:145], v160 offset:1408
    v_mfma_f32_16x16x32_bf16 v[68:71], v[132:135], v[124:127], v[68:71]
    ds_read_b64 v[146:147], v160 offset:1416
    ds_read_b128 v[148:151], v161 offset:2944
    v_mfma_f32_16x16x32_bf16 v[72:75], v[108:111], v[136:139], v[72:75]
    ds_read_b64 v[152:153], v160 offset:1920
    v_mfma_f32_16x16x32_bf16 v[72:75], v[128:131], v[124:127], v[72:75]
    ds_read_b64 v[154:155], v160 offset:1928
    s_waitcnt lgkmcnt(8)
    v_mfma_f32_16x16x32_bf16 v[72:75], v[132:135], v[104:107], v[72:75]
    ds_read_b128 v[156:159], v161 offset:2432
    v_mfma_f32_16x16x32_bf16 v[76:79], v[100:103], v[136:139], v[76:79]
    ds_read_b128 v[100:103], v161 offset:3904
    v_mfma_f32_16x16x32_bf16 v[76:79], v[108:111], v[124:127], v[76:79]
    ds_read_b64 v[136:137], v160 offset:320
    v_mfma_f32_16x16x32_bf16 v[76:79], v[128:131], v[104:107], v[76:79]
    ds_read_b64 v[138:139], v160 offset:328
    v_mfma_f32_16x16x32_bf16 v[76:79], v[132:135], v[96:99], v[76:79]
    ds_read_b64 v[108:109], v160 offset:832
    v_mfma_f32_16x16x32_bf16 v[64:67], v[120:123], v[140:143], v[64:67]
    ds_read_b64 v[110:111], v160 offset:840
    ds_read_b128 v[124:127], v161 offset:3392
    s_waitcnt lgkmcnt(7)
    v_mfma_f32_16x16x32_bf16 v[68:71], v[116:119], v[140:143], v[68:71]
    ds_read_b64 v[128:129], v160 offset:1344
    v_mfma_f32_16x16x32_bf16 v[68:71], v[120:123], v[112:115], v[68:71]
    ds_read_b64 v[130:131], v160 offset:1352
    ds_read_b128 v[104:107], v161 offset:2880
    v_mfma_f32_16x16x32_bf16 v[72:75], v[144:147], v[140:143], v[72:75]
    ds_read_b64 v[132:133], v160 offset:1856
    v_mfma_f32_16x16x32_bf16 v[72:75], v[116:119], v[112:115], v[72:75]
    ds_read_b64 v[134:135], v160 offset:1864
    v_mfma_f32_16x16x32_bf16 v[72:75], v[120:123], v[148:151], v[72:75]
    ds_read_b128 v[96:99], v161 offset:2368
    v_mfma_f32_16x16x32_bf16 v[76:79], v[152:155], v[140:143], v[76:79]
    ds_read_b128 v[152:155], v161 offset:3840
    v_mfma_f32_16x16x32_bf16 v[76:79], v[144:147], v[112:115], v[76:79]
    ds_read_b64 v[140:141], v160 offset:256
    v_mfma_f32_16x16x32_bf16 v[76:79], v[116:119], v[148:151], v[76:79]
    ds_read_b64 v[142:143], v160 offset:264
    s_waitcnt lgkmcnt(6)
    v_mfma_f32_16x16x32_bf16 v[76:79], v[120:123], v[156:159], v[76:79]
    ds_read_b64 v[144:145], v160 offset:768
    v_mfma_f32_16x16x32_bf16 v[64:67], v[136:139], v[100:103], v[64:67]
    ds_read_b64 v[146:147], v160 offset:776
    ds_read_b128 v[112:115], v161 offset:3328
    v_mfma_f32_16x16x32_bf16 v[68:71], v[108:111], v[100:103], v[68:71]
    ds_read_b64 v[116:117], v160 offset:1280
    v_mfma_f32_16x16x32_bf16 v[68:71], v[136:139], v[124:127], v[68:71]
    ds_read_b64 v[118:119], v160 offset:1288
    ds_read_b128 v[148:151], v161 offset:2816
    v_mfma_f32_16x16x32_bf16 v[72:75], v[128:131], v[100:103], v[72:75]
    ds_read_b64 v[120:121], v160 offset:1792
    v_mfma_f32_16x16x32_bf16 v[72:75], v[108:111], v[124:127], v[72:75]
    ds_read_b64 v[122:123], v160 offset:1800
    v_mfma_f32_16x16x32_bf16 v[72:75], v[136:139], v[104:107], v[72:75]
    ds_read_b128 v[156:159], v161 offset:2304
    s_waitcnt lgkmcnt(8)
    v_mfma_f32_16x16x32_bf16 v[76:79], v[132:135], v[100:103], v[76:79]
    ds_read_b64 v[132:133], v160 offset:3840
    v_mfma_f32_16x16x32_bf16 v[76:79], v[128:131], v[124:127], v[76:79]
    ds_read_b64 v[134:135], v160 offset:3848
    v_mfma_f32_16x16x32_bf16 v[76:79], v[108:111], v[104:107], v[76:79]
    ds_read_b64 v[100:101], v160 offset:3328
    v_mfma_f32_16x16x32_bf16 v[76:79], v[136:139], v[96:99], v[76:79]
    ds_read_b64 v[102:103], v160 offset:3336
    v_mfma_f32_16x16x32_bf16 v[64:67], v[140:143], v[152:155], v[64:67]
    ds_read_b64 v[128:129], v160 offset:2816
    s_waitcnt lgkmcnt(6)
    v_mfma_f32_16x16x32_bf16 v[68:71], v[144:147], v[152:155], v[68:71]
    ds_read_b64 v[130:131], v160 offset:2824
    v_mfma_f32_16x16x32_bf16 v[68:71], v[140:143], v[112:115], v[68:71]
    ds_read_b64 v[124:125], v160 offset:2304
    v_mfma_f32_16x16x32_bf16 v[72:75], v[116:119], v[152:155], v[72:75]
    ds_read_b64 v[126:127], v160 offset:2312
    v_mfma_f32_16x16x32_bf16 v[72:75], v[144:147], v[112:115], v[72:75]
    ds_read_b128 v[108:111], v161 offset:1792
    v_mfma_f32_16x16x32_bf16 v[72:75], v[140:143], v[148:151], v[72:75]
    ds_read_b128 v[104:107], v161 offset:1280
    v_mfma_f32_16x16x32_bf16 v[76:79], v[120:123], v[152:155], v[76:79]
    ds_read_b128 v[136:139], v161 offset:768
    v_mfma_f32_16x16x32_bf16 v[76:79], v[116:119], v[112:115], v[76:79]
    v_cvt_pk_bf16_f32 v44, v64, v65
    v_cvt_pk_bf16_f32 v45, v66, v67
    ds_write_b64 v162, v[44:45] offset:0
    v_mfma_f32_16x16x32_bf16 v[76:79], v[144:147], v[148:151], v[76:79]
    ds_read_b128 v[96:99], v161 offset:256
    s_waitcnt lgkmcnt(6)
    v_mfma_f32_16x16x32_bf16 v[76:79], v[140:143], v[156:159], v[76:79]
    v_mfma_f32_16x16x32_bf16 v[88:91], v[120:123], v[156:159], v[88:91]
    v_cvt_pk_bf16_f32 v46, v68, v69
    v_cvt_pk_bf16_f32 v47, v70, v71
    ds_write_b64 v162, v[46:47] offset:640
    v_mfma_f32_16x16x32_bf16 v[84:87], v[120:123], v[148:151], v[84:87]
    v_mfma_f32_16x16x32_bf16 v[84:87], v[116:119], v[156:159], v[84:87]
    v_mfma_f32_16x16x32_bf16 v[80:83], v[120:123], v[112:115], v[80:83]
    v_cvt_pk_bf16_f32 v48, v72, v73
    v_cvt_pk_bf16_f32 v49, v74, v75
    ds_write_b64 v162, v[48:49] offset:1280
    v_mfma_f32_16x16x32_bf16 v[80:83], v[116:119], v[148:151], v[80:83]
    v_mfma_f32_16x16x32_bf16 v[80:83], v[144:147], v[156:159], v[80:83]
    v_mfma_f32_16x16x32_bf16 v[92:95], v[132:135], v[152:155], v[92:95]
    v_cvt_pk_bf16_f32 v50, v76, v77
    v_cvt_pk_bf16_f32 v51, v78, v79
    ds_write_b64 v162, v[50:51] offset:1920
    s_mov_b64 exec, 1
    ds_add_u32 v30, v31 offset:4
    s_mov_b64 exec, -1
    v_mfma_f32_16x16x32_bf16 v[92:95], v[100:103], v[112:115], v[92:95]
    ds_read_b128 v[132:135], v161 offset:3904
    v_mfma_f32_16x16x32_bf16 v[92:95], v[128:131], v[148:151], v[92:95]
    s_waitcnt lgkmcnt(4)
    v_mfma_f32_16x16x32_bf16 v[92:95], v[124:127], v[156:159], v[92:95]
    ds_read_b64 v[156:157], v160 offset:3904
    v_mfma_f32_16x16x32_bf16 v[88:91], v[100:103], v[152:155], v[88:91]
    ds_read_b64 v[158:159], v160 offset:3912
    v_mfma_f32_16x16x32_bf16 v[88:91], v[128:131], v[112:115], v[88:91]
    ds_read_b128 v[100:103], v161 offset:3392
    v_mfma_f32_16x16x32_bf16 v[88:91], v[124:127], v[148:151], v[88:91]
    ds_read_b64 v[148:149], v160 offset:3392
    v_mfma_f32_16x16x32_bf16 v[84:87], v[128:131], v[152:155], v[84:87]
    ds_read_b64 v[150:151], v160 offset:3400
    v_mfma_f32_16x16x32_bf16 v[84:87], v[124:127], v[112:115], v[84:87]
    ds_read_b128 v[128:131], v161 offset:2880
    v_mfma_f32_16x16x32_bf16 v[80:83], v[124:127], v[152:155], v[80:83]
    ds_read_b64 v[112:113], v160 offset:2880
    v_mfma_f32_16x16x32_bf16 v[80:83], v[140:143], v[108:111], v[80:83]
    ds_read_b64 v[114:115], v160 offset:2888
    v_mfma_f32_16x16x32_bf16 v[84:87], v[144:147], v[108:111], v[84:87]
    ds_read_b128 v[124:127], v161 offset:2368
    v_mfma_f32_16x16x32_bf16 v[84:87], v[140:143], v[104:107], v[84:87]
    ds_read_b64 v[152:153], v160 offset:2368
    ds_read_b64 v[154:155], v160 offset:2376
    v_mfma_f32_16x16x32_bf16 v[88:91], v[116:119], v[108:111], v[88:91]
    v_mfma_f32_16x16x32_bf16 v[88:91], v[144:147], v[104:107], v[88:91]
    v_mfma_f32_16x16x32_bf16 v[88:91], v[140:143], v[136:139], v[88:91]
    v_mfma_f32_16x16x32_bf16 v[92:95], v[120:123], v[108:111], v[92:95]
    ds_read_b64 v[120:121], v160 offset:1856
    v_mfma_f32_16x16x32_bf16 v[92:95], v[116:119], v[104:107], v[92:95]
    ds_read_b64 v[122:123], v160 offset:1864
    v_mfma_f32_16x16x32_bf16 v[92:95], v[144:147], v[136:139], v[92:95]
    ds_read_b64 v[108:109], v160 offset:1344
    v_mfma_f32_16x16x32_bf16 v[92:95], v[140:143], v[96:99], v[92:95]
    ds_read_b64 v[110:111], v160 offset:1352
    s_waitcnt lgkmcnt(4)
    v_mfma_f32_16x16x32_bf16 v[92:95], v[156:159], v[132:135], v[92:95]
    ds_read_b64 v[116:117], v160 offset:832
    v_mfma_f32_16x16x32_bf16 v[92:95], v[148:151], v[100:103], v[92:95]
    ds_read_b64 v[118:119], v160 offset:840
    v_mfma_f32_16x16x32_bf16 v[92:95], v[112:115], v[128:131], v[92:95]
    ds_read_b128 v[104:107], v161 offset:1856
    v_mfma_f32_16x16x32_bf16 v[92:95], v[152:155], v[124:127], v[92:95]
    ds_read_b64 v[144:145], v160 offset:320
    v_mfma_f32_16x16x32_bf16 v[88:91], v[148:151], v[132:135], v[88:91]
    ds_read_b64 v[146:147], v160 offset:328
    v_mfma_f32_16x16x32_bf16 v[88:91], v[112:115], v[100:103], v[88:91]
    ds_read_b128 v[136:139], v161 offset:1344
    v_mfma_f32_16x16x32_bf16 v[88:91], v[152:155], v[128:131], v[88:91]
    ds_read_b128 v[140:143], v161 offset:832
    v_mfma_f32_16x16x32_bf16 v[84:87], v[112:115], v[132:135], v[84:87]
    ds_read_b128 v[96:99], v161 offset:320
    v_mfma_f32_16x16x32_bf16 v[84:87], v[152:155], v[100:103], v[84:87]
    ds_read_b128 v[156:159], v161 offset:3968
    v_mfma_f32_16x16x32_bf16 v[80:83], v[152:155], v[132:135], v[80:83]
    ds_read_b64 v[148:149], v160 offset:3968
    s_waitcnt lgkmcnt(6)
    v_mfma_f32_16x16x32_bf16 v[88:91], v[120:123], v[124:127], v[88:91]
    ds_read_b64 v[150:151], v160 offset:3976
    v_mfma_f32_16x16x32_bf16 v[84:87], v[120:123], v[128:131], v[84:87]
    ds_read_b128 v[112:115], v161 offset:3456
    v_mfma_f32_16x16x32_bf16 v[84:87], v[108:111], v[124:127], v[84:87]
    ds_read_b64 v[152:153], v160 offset:3456
    v_mfma_f32_16x16x32_bf16 v[80:83], v[120:123], v[100:103], v[80:83]
    ds_read_b64 v[154:155], v160 offset:3464
    v_mfma_f32_16x16x32_bf16 v[80:83], v[108:111], v[128:131], v[80:83]
    ds_read_b128 v[132:135], v161 offset:2944
    v_mfma_f32_16x16x32_bf16 v[80:83], v[116:119], v[124:127], v[80:83]
    ds_read_b64 v[100:101], v160 offset:2944
    s_waitcnt lgkmcnt(6)
    v_mfma_f32_16x16x32_bf16 v[80:83], v[144:147], v[104:107], v[80:83]
    ds_read_b64 v[102:103], v160 offset:2952
    v_mfma_f32_16x16x32_bf16 v[84:87], v[116:119], v[104:107], v[84:87]
    ds_read_b128 v[128:131], v161 offset:2432
    v_mfma_f32_16x16x32_bf16 v[84:87], v[144:147], v[136:139], v[84:87]
    ds_read_b64 v[124:125], v160 offset:2432
    ds_read_b64 v[126:127], v160 offset:2440
    v_mfma_f32_16x16x32_bf16 v[88:91], v[108:111], v[104:107], v[88:91]
    v_mfma_f32_16x16x32_bf16 v[88:91], v[116:119], v[136:139], v[88:91]
    v_mfma_f32_16x16x32_bf16 v[88:91], v[144:147], v[140:143], v[88:91]
    v_mfma_f32_16x16x32_bf16 v[92:95], v[120:123], v[104:107], v[92:95]
    ds_read_b64 v[120:121], v160 offset:1920
    v_mfma_f32_16x16x32_bf16 v[92:95], v[108:111], v[136:139], v[92:95]
    ds_read_b64 v[122:123], v160 offset:1928
    v_mfma_f32_16x16x32_bf16 v[92:95], v[116:119], v[140:143], v[92:95]
    ds_read_b64 v[104:105], v160 offset:1408
    v_mfma_f32_16x16x32_bf16 v[92:95], v[144:147], v[96:99], v[92:95]
    ds_read_b64 v[106:107], v160 offset:1416
    s_waitcnt lgkmcnt(4)
    v_mfma_f32_16x16x32_bf16 v[92:95], v[148:151], v[156:159], v[92:95]
    ds_read_b64 v[108:109], v160 offset:896
    v_mfma_f32_16x16x32_bf16 v[92:95], v[152:155], v[112:115], v[92:95]
    ds_read_b64 v[110:111], v160 offset:904
    v_mfma_f32_16x16x32_bf16 v[92:95], v[100:103], v[132:135], v[92:95]
    ds_read_b128 v[136:139], v161 offset:1920
    v_mfma_f32_16x16x32_bf16 v[92:95], v[124:127], v[128:131], v[92:95]
    ds_read_b64 v[116:117], v160 offset:384
    v_mfma_f32_16x16x32_bf16 v[88:91], v[152:155], v[156:159], v[88:91]
    ds_read_b64 v[118:119], v160 offset:392
    v_mfma_f32_16x16x32_bf16 v[88:91], v[100:103], v[112:115], v[88:91]
    ds_read_b128 v[140:143], v161 offset:1408
    v_mfma_f32_16x16x32_bf16 v[88:91], v[124:127], v[132:135], v[88:91]
    ds_read_b128 v[144:147], v161 offset:896
    v_mfma_f32_16x16x32_bf16 v[84:87], v[100:103], v[156:159], v[84:87]
    ds_read_b128 v[96:99], v161 offset:384
    v_mfma_f32_16x16x32_bf16 v[84:87], v[124:127], v[112:115], v[84:87]
    ds_read_b128 v[148:151], v161 offset:4032
    v_mfma_f32_16x16x32_bf16 v[80:83], v[124:127], v[156:159], v[80:83]
    ds_read_b64 v[152:153], v160 offset:4032
    s_waitcnt lgkmcnt(6)
    v_mfma_f32_16x16x32_bf16 v[88:91], v[120:123], v[128:131], v[88:91]
    ds_read_b64 v[154:155], v160 offset:4040
    v_mfma_f32_16x16x32_bf16 v[84:87], v[120:123], v[132:135], v[84:87]
    ds_read_b128 v[100:103], v161 offset:3520
    v_mfma_f32_16x16x32_bf16 v[84:87], v[104:107], v[128:131], v[84:87]
    ds_read_b64 v[124:125], v160 offset:3520
    v_mfma_f32_16x16x32_bf16 v[80:83], v[120:123], v[112:115], v[80:83]
    ds_read_b64 v[126:127], v160 offset:3528
    v_mfma_f32_16x16x32_bf16 v[80:83], v[104:107], v[132:135], v[80:83]
    ds_read_b128 v[156:159], v161 offset:3008
    v_mfma_f32_16x16x32_bf16 v[80:83], v[108:111], v[128:131], v[80:83]
    ds_read_b64 v[112:113], v160 offset:3008
    s_waitcnt lgkmcnt(6)
    v_mfma_f32_16x16x32_bf16 v[80:83], v[116:119], v[136:139], v[80:83]
    ds_read_b64 v[114:115], v160 offset:3016
    v_mfma_f32_16x16x32_bf16 v[84:87], v[108:111], v[136:139], v[84:87]
    ds_read_b128 v[132:135], v161 offset:2496
    v_mfma_f32_16x16x32_bf16 v[84:87], v[116:119], v[140:143], v[84:87]
    ds_read_b64 v[128:129], v160 offset:2496
    ds_read_b64 v[130:131], v160 offset:2504
    v_mfma_f32_16x16x32_bf16 v[88:91], v[104:107], v[136:139], v[88:91]
    v_mfma_f32_16x16x32_bf16 v[88:91], v[108:111], v[140:143], v[88:91]
    v_mfma_f32_16x16x32_bf16 v[88:91], v[116:119], v[144:147], v[88:91]
    v_mfma_f32_16x16x32_bf16 v[92:95], v[120:123], v[136:139], v[92:95]
    ds_read_b64 v[120:121], v160 offset:1984
    v_mfma_f32_16x16x32_bf16 v[92:95], v[104:107], v[140:143], v[92:95]
    ds_read_b64 v[122:123], v160 offset:1992
    v_mfma_f32_16x16x32_bf16 v[92:95], v[108:111], v[144:147], v[92:95]
    ds_read_b64 v[136:137], v160 offset:1472
    v_mfma_f32_16x16x32_bf16 v[92:95], v[116:119], v[96:99], v[92:95]
    ds_read_b64 v[138:139], v160 offset:1480
    s_waitcnt lgkmcnt(4)
    v_mfma_f32_16x16x32_bf16 v[92:95], v[152:155], v[148:151], v[92:95]
    ds_read_b64 v[104:105], v160 offset:960
    v_mfma_f32_16x16x32_bf16 v[92:95], v[124:127], v[100:103], v[92:95]
    ds_read_b64 v[106:107], v160 offset:968
    v_mfma_f32_16x16x32_bf16 v[92:95], v[112:115], v[156:159], v[92:95]
    ds_read_b128 v[140:143], v161 offset:1984
    v_mfma_f32_16x16x32_bf16 v[92:95], v[128:131], v[132:135], v[92:95]
    ds_read_b64 v[108:109], v160 offset:448
    v_mfma_f32_16x16x32_bf16 v[88:91], v[124:127], v[148:151], v[88:91]
    ds_read_b64 v[110:111], v160 offset:456
    v_mfma_f32_16x16x32_bf16 v[88:91], v[112:115], v[100:103], v[88:91]
    ds_read_b128 v[144:147], v161 offset:1472
    v_mfma_f32_16x16x32_bf16 v[88:91], v[128:131], v[156:159], v[88:91]
    ds_read_b128 v[116:119], v161 offset:960
    v_mfma_f32_16x16x32_bf16 v[84:87], v[112:115], v[148:151], v[84:87]
    ds_read_b128 v[96:99], v161 offset:448
    v_mfma_f32_16x16x32_bf16 v[84:87], v[128:131], v[100:103], v[84:87]
    v_mfma_f32_16x16x32_bf16 v[80:83], v[128:131], v[148:151], v[80:83]
    s_waitcnt lgkmcnt(4)
    v_mfma_f32_16x16x32_bf16 v[88:91], v[120:123], v[132:135], v[88:91]
    v_mfma_f32_16x16x32_bf16 v[84:87], v[120:123], v[156:159], v[84:87]
    v_mfma_f32_16x16x32_bf16 v[84:87], v[136:139], v[132:135], v[84:87]
    v_mfma_f32_16x16x32_bf16 v[80:83], v[120:123], v[100:103], v[80:83]
    v_mfma_f32_16x16x32_bf16 v[80:83], v[136:139], v[156:159], v[80:83]
    v_mfma_f32_16x16x32_bf16 v[80:83], v[104:107], v[132:135], v[80:83]
    s_waitcnt lgkmcnt(0)
    v_mfma_f32_16x16x32_bf16 v[80:83], v[108:111], v[140:143], v[80:83]
    v_mfma_f32_16x16x32_bf16 v[84:87], v[104:107], v[140:143], v[84:87]
    v_mfma_f32_16x16x32_bf16 v[84:87], v[108:111], v[144:147], v[84:87]
    v_mfma_f32_16x16x32_bf16 v[88:91], v[136:139], v[140:143], v[88:91]
    v_mfma_f32_16x16x32_bf16 v[88:91], v[104:107], v[144:147], v[88:91]
    v_mfma_f32_16x16x32_bf16 v[88:91], v[108:111], v[116:119], v[88:91]
    s_nop 2
    v_cvt_pk_bf16_f32 v52, v80, v81
    v_cvt_pk_bf16_f32 v53, v82, v83
    ds_write_b64 v162, v[52:53] offset:2560
    v_mfma_f32_16x16x32_bf16 v[92:95], v[120:123], v[140:143], v[92:95]
    v_mfma_f32_16x16x32_bf16 v[92:95], v[136:139], v[144:147], v[92:95]
    v_cvt_pk_bf16_f32 v54, v84, v85
    v_cvt_pk_bf16_f32 v55, v86, v87
    ds_write_b64 v162, v[54:55] offset:3200
    v_mfma_f32_16x16x32_bf16 v[92:95], v[104:107], v[116:119], v[92:95]
    v_mfma_f32_16x16x32_bf16 v[92:95], v[108:111], v[96:99], v[92:95]
    v_cvt_pk_bf16_f32 v56, v88, v89
    v_cvt_pk_bf16_f32 v57, v90, v91
    ds_write_b64 v162, v[56:57] offset:3840
    s_nop 4
    v_cvt_pk_bf16_f32 v58, v92, v93
    v_cvt_pk_bf16_f32 v59, v94, v95
    ds_write_b64 v162, v[58:59] offset:4480
    s_mov_b64 exec, 1
    ds_add_rtn_u32 v60, v30, v31
    s_mov_b32 s72, 3
    s_mov_b32 s79, 0
L_zs_7:
    s_waitcnt lgkmcnt(0)
    v_cmp_eq_u32 vcc, s72, v60
    s_cbranch_vccnz L_zs_done_8
    ds_read_b32 v60, v30 offset:0
    s_mov_b32 s72, 4
    s_add_u32 s79, s79, 1
    s_cmp_gt_u32 s79, 8388608
    s_cbranch_scc0 L_zs_7
L_zs_done_8:
    s_mov_b64 exec, -1
    ds_read2st64_b32 v[80:81], v15 offset0:10 offset1:30
    ds_read2st64_b32 v[82:83], v15 offset0:50 offset1:70
    ds_read2st64_b32 v[84:85], v16 offset0:10 offset1:30
    ds_read2st64_b32 v[86:87], v16 offset0:50 offset1:70
    s_waitcnt lgkmcnt(2)
    buffer_store_dwordx4 v[80:83], v11, s[16:19], s81 offen offset:0 sc1
    s_waitcnt lgkmcnt(0)
    buffer_store_dwordx4 v[84:87], v11, s[16:19], s81 offen offset:1024 sc1
    s_setprio 0
L_zjoin:
    s_cmp_ge_u32 s2, 128
    s_cbranch_scc1 L_end
L_zjoin2:
    v_mov_b32 v158, 0x4083126f
    s_mul_i32 s72, s61, 352256
    s_lshl_b32 s73, s59, 7
    s_add_u32 s72, s72, s73
    s_add_u32 s81, s72, 2097152
    s_add_u32 s80, s81, 22016
    s_mul_i32 s73, s59, 20480
    s_cmp_lt_u32 s59, 64
    s_cbranch_scc1 L_noack
    s_waitcnt vmcnt(0)
L_noack:
    s_waitcnt lgkmcnt(0)
    s_barrier
    buffer_load_dwordx4 v[128:131], v21, s[16:19], s81 offen sc1
    buffer_load_dwordx4 v[132:135], v21, s[16:19], s80 offen sc1
    ds_read_b128 v[32:35], v18
    ds_read_b128 v[36:39], v18 offset:1312
    ds_read_b128 v[40:43], v19
    ds_read_b128 v[136:139], v20 offset:0
    ds_read_b128 v[140:143], v20 offset:16
    ds_read_b128 v[144:147], v20 offset:2560
    ds_read_b128 v[148:151], v20 offset:2576
    ds_read_b128 v[76:79], v13
    s_lshl_b32 s72, s61, 7
    s_add_u32 s76, s72, s73
    s_add_u32 s77, s76, 10240
    s_mul_i32 s73, s59, 1280
    s_add_u32 s73, s73, s72
    s_lshr_b32 s75, s59, 2
    s_mul_i32 s75, s75, 8192
    s_mul_i32 s74, s59, 2048
    s_add_u32 s74, s74, s75
    s_add_u32 s74, s74, s72
    s_add_u32 s74, s74, 6815744
    s_lshl_b32 s73, s73, 2
    s_add_u32 s75, s73, 393216
    s_lshr_b32 s78, s59, 5
    s_mul_i32 s78, s78, 8192
    s_mul_i32 s73, s59, 256
    s_add_u32 s73, s73, s78
    s_add_u32 s78, s73, 6291456
    s_mov_b32 s82, s60
    s_mov_b32 s64, 0x44200000
    s_mov_b32 s65, s64
    s_mov_b32 s68, 0xfffff800
    s_mov_b32 s69, 0x80000000
    s_waitcnt lgkmcnt(5)
    v_lshlrev_b32 v96, 16, v32
    v_lshlrev_b32 v97, 16, v36
    v_and_b32 v98, v29, v32
    v_and_b32 v99, v29, v36
    v_lshlrev_b32 v100, 16, v33
    v_lshlrev_b32 v101, 16, v37
    v_and_b32 v102, v29, v33
    v_and_b32 v103, v29, v37
    v_lshlrev_b32 v104, 16, v34
    v_lshlrev_b32 v105, 16, v38
    v_and_b32 v106, v29, v34
    v_and_b32 v107, v29, v38
    v_lshlrev_b32 v108, 16, v35
    v_lshlrev_b32 v109, 16, v39
    v_and_b32 v110, v29, v35
    v_and_b32 v111, v29, v39
    v_pk_fma_f32 v[112:113], v[96:97], v[40:41], v[42:43]
    v_pk_fma_f32 v[114:115], v[98:99], v[40:41], v[42:43]
    v_pk_fma_f32 v[116:117], v[100:101], v[40:41], v[42:43]
    v_pk_fma_f32 v[118:119], v[102:103], v[40:41], v[42:43]
    v_pk_fma_f32 v[120:121], v[104:105], v[40:41], v[42:43]
    v_pk_fma_f32 v[122:123], v[106:107], v[40:41], v[42:43]
    v_pk_fma_f32 v[124:125], v[108:109], v[40:41], v[42:43]
    v_pk_fma_f32 v[126:127], v[110:111], v[40:41], v[42:43]
    s_waitcnt lgkmcnt(0)
    v_pk_fma_f32 v[112:113], v[112:113], v[136:137], v[144:145] op_sel:[0,0,0] op_sel_hi:[1,0,0]
    v_pk_fma_f32 v[114:115], v[114:115], v[136:137], v[144:145] op_sel:[0,1,1] op_sel_hi:[1,1,1]
    v_pk_fma_f32 v[116:117], v[116:117], v[138:139], v[146:147] op_sel:[0,0,0] op_sel_hi:[1,0,0]
    v_pk_fma_f32 v[118:119], v[118:119], v[138:139], v[146:147] op_sel:[0,1,1] op_sel_hi:[1,1,1]
    v_pk_fma_f32 v[120:121], v[120:121], v[140:141], v[148:149] op_sel:[0,0,0] op_sel_hi:[1,0,0]
    v_pk_fma_f32 v[122:123], v[122:123], v[140:141], v[148:149] op_sel:[0,1,1] op_sel_hi:[1,1,1]
    v_pk_fma_f32 v[124:125], v[124:125], v[142:143], v[150:151] op_sel:[0,0,0] op_sel_hi:[1,0,0]
    v_pk_fma_f32 v[126:127], v[126:127], v[142:143], v[150:151] op_sel:[0,1,1] op_sel_hi:[1,1,1]
    v_cvt_f32_f64 v76, v[76:77]
    v_cvt_f32_f64 v77, v[78:79]
    ds_read_b128 v[68:71], v20 offset:12800
    ds_read_b128 v[72:75], v20 offset:12816
    ds_read_b128 v[44:47], v20 offset:5120
    ds_read_b128 v[48:51], v20 offset:5136
    ds_read_b128 v[52:55], v20 offset:7680
    ds_read_b128 v[56:59], v20 offset:7696
    ds_read_b128 v[60:63], v20 offset:10240
    ds_read_b128 v[64:67], v20 offset:10256
    s_mov_b32 s79, 0
L_z_9:
    s_waitcnt vmcnt(0)
    v_cmp_eq_u32 vcc, s82, v131
    v_cmp_eq_u32 s[70:71], s82, v135
    v_lshlrev_b32 v136, 16, v128
    v_and_b32 v137, v29, v128
    v_lshlrev_b32 v138, 16, v129
    v_and_b32 v139, v29, v129
    v_lshlrev_b32 v140, 16, v130
    v_and_b32 v141, v29, v130
    v_lshlrev_b32 v142, 16, v131
    v_and_b32 v143, v29, v131
    s_or_b64 vcc, vcc, s[70:71]
    s_cbranch_scc0 L_z_done_10
    s_mov_b64 exec, vcc
    buffer_load_dwordx4 v[128:131], v21, s[16:19], s81 offen sc1
    buffer_load_dwordx4 v[132:135], v21, s[16:19], s80 offen sc1
    s_mov_b64 exec, -1
    s_add_u32 s79, s79, 1
    s_cmp_gt_u32 s79, 524288
    s_cbranch_scc0 L_z_9
    s_waitcnt vmcnt(0)
L_z_done_10:
    s_waitcnt lgkmcnt(0)
    v_pk_fma_f32 v[96:97], v[112:113], v[136:137], v[96:97]
    v_pk_fma_f32 v[98:99], v[114:115], v[138:139], v[98:99]
    v_pk_fma_f32 v[100:101], v[116:117], v[140:141], v[100:101]
    v_pk_fma_f32 v[102:103], v[118:119], v[142:143], v[102:103]
    v_pk_mul_f32 v[154:155], v[96:97], v[96:97]
    v_pk_mul_f32 v[156:157], v[96:97], v[68:69] op_sel:[0,0] op_sel_hi:[1,0]
    v_pk_add_f32 v[152:153], v[96:97], v[98:99]
    v_pk_fma_f32 v[154:155], v[98:99], v[98:99], v[154:155]
    v_pk_fma_f32 v[156:157], v[98:99], v[68:69], v[156:157] op_sel:[0,1,0] op_sel_hi:[1,1,1]
    v_pk_add_f32 v[152:153], v[152:153], v[100:101]
    v_pk_fma_f32 v[154:155], v[100:101], v[100:101], v[154:155]
    v_pk_fma_f32 v[156:157], v[100:101], v[70:71], v[156:157] op_sel:[0,0,0] op_sel_hi:[1,0,1]
    v_pk_add_f32 v[152:153], v[152:153], v[102:103]
    v_pk_fma_f32 v[154:155], v[102:103], v[102:103], v[154:155]
    v_pk_fma_f32 v[156:157], v[102:103], v[70:71], v[156:157] op_sel:[0,1,0] op_sel_hi:[1,1,1]
    v_lshlrev_b32 v144, 16, v132
    v_and_b32 v145, v29, v132
    v_lshlrev_b32 v146, 16, v133
    v_and_b32 v147, v29, v133
    v_lshlrev_b32 v148, 16, v134
    v_and_b32 v149, v29, v134
    v_lshlrev_b32 v150, 16, v135
    v_and_b32 v151, v29, v135
    v_pk_fma_f32 v[104:105], v[120:121], v[144:145], v[104:105]
    v_pk_fma_f32 v[106:107], v[122:123], v[146:147], v[106:107]
    v_pk_fma_f32 v[108:109], v[124:125], v[148:149], v[108:109]
    v_pk_fma_f32 v[110:111], v[126:127], v[150:151], v[110:111]
    v_pk_add_f32 v[152:153], v[152:153], v[104:105]
    v_pk_fma_f32 v[154:155], v[104:105], v[104:105], v[154:155]
    v_pk_fma_f32 v[156:157], v[104:105], v[72:73], v[156:157] op_sel:[0,0,0] op_sel_hi:[1,0,1]
    v_pk_add_f32 v[152:153], v[152:153], v[106:107]
    v_pk_fma_f32 v[154:155], v[106:107], v[106:107], v[154:155]
    v_pk_fma_f32 v[156:157], v[106:107], v[72:73], v[156:157] op_sel:[0,1,0] op_sel_hi:[1,1,1]
    v_pk_add_f32 v[152:153], v[152:153], v[108:109]
    v_pk_fma_f32 v[154:155], v[108:109], v[108:109], v[154:155]
    v_pk_fma_f32 v[156:157], v[108:109], v[74:75], v[156:157] op_sel:[0,0,0] op_sel_hi:[1,0,1]
    v_pk_add_f32 v[152:153], v[152:153], v[110:111]
    v_pk_fma_f32 v[154:155], v[110:111], v[110:111], v[154:155]
    v_pk_fma_f32 v[156:157], v[110:111], v[74:75], v[156:157] op_sel:[0,1,0] op_sel_hi:[1,1,1]
    v_permlane32_swap_b32 v152, v153
    v_permlane32_swap_b32 v154, v155
    v_permlane32_swap_b32 v156, v157
    v_add_f32 v152, v152, v153
    v_add_f32 v154, v154, v155
    v_add_f32 v156, v156, v157
    s_nop 0
    v_permlane16_swap_b32 v152, v154
    v_add_f32_dpp v156, v156, v156 row_ror:8 row_mask:0xf bank_mask:0xc
    v_add_f32 v152, v152, v154
    s_nop 1
    v_add_f32_dpp v156, v152, v152 row_ror:8 row_mask:0xf bank_mask:0x3
    v_cvt_f64_f32 v[152:153], v156
    ds_add_f64 v22, v[152:153]
    s_waitcnt lgkmcnt(0)
    s_barrier
    ds_read_b128 v[128:131], v23
    ds_read_b128 v[132:135], v23 offset:16
    ds_read_b128 v[152:155], v23 offset:32
    s_waitcnt lgkmcnt(1)
    v_cvt_f32_f64 v32, v[128:129]
    v_cvt_f32_f64 v33, v[130:131]
    v_cvt_f32_f64 v34, v[132:133]
    v_cvt_f32_f64 v35, v[134:135]
    v_pk_fma_f32 v[34:35], v[34:35], s[64:65], v[158:159] op_sel_hi:[1,1,0]
    v_pk_fma_f32 v[34:35], v[32:33], v[32:33], v[34:35] neg_lo:[1,0,0] neg_hi:[1,0,0]
    v_max_f32 v34, v158, v34
    v_max_f32 v35, v158, v35
    v_rsq_f32 v34, v34
    v_rsq_f32 v35, v35
    s_waitcnt lgkmcnt(0)
    v_cvt_f32_f64 v36, v[152:153]
    v_cvt_f32_f64 v37, v[154:155]
    v_pk_fma_f32 v[36:37], v[32:33], v[76:77], v[36:37] op_sel_hi:[1,0,1] neg_lo:[1,0,0] neg_hi:[1,0,0]
    v_pk_fma_f32 v[36:37], v[36:37], v[34:35], v[76:77] op_sel:[0,0,1] op_sel_hi:[1,1,1]
    v_and_or_b32 v36, v36, s68, v24
    v_and_or_b32 v37, v37, s68, v8
    v_max_f32 v36, v36, v37
    s_cmp_lg_u32 s61, 2
    s_nop 0
    v_max_f32_dpp v36, v36, v36 quad_perm:[1,0,3,2] row_mask:0xf bank_mask:0xf
    v_pk_mul_f32 v[32:33], v[32:33], v[34:35] neg_lo:[1,0] neg_hi:[1,0]
    s_nop 0
    v_max_f32_dpp v36, v36, v36 quad_perm:[2,3,0,1] row_mask:0xf bank_mask:0xf
    v_pk_mul_f32 v[34:35], v[34:35], s[64:65]
    s_nop 0
    v_max_f32_dpp v36, v36, v36 row_half_mirror row_mask:0xf bank_mask:0xf
    s_cbranch_scc1 L_nokey
    v_ashrrev_i32 v38, 31, v36
    v_bitop3_b32 v166, v36, v38, s69 bitop3:0x1e
    s_mov_b64 exec, 0xffff
    buffer_store_dwordx2 v[166:167], v7, s[16:19], s78 offen sc1
    s_mov_b64 exec, -1
L_nokey:
    v_readfirstlane_b32 s72, v36
    v_pk_fma_f32 v[136:137], v[96:97], v[34:35], v[32:33]
    v_pk_fma_f32 v[138:139], v[98:99], v[34:35], v[32:33]
    v_pk_fma_f32 v[140:141], v[100:101], v[34:35], v[32:33]
    v_pk_fma_f32 v[142:143], v[102:103], v[34:35], v[32:33]
    v_pk_fma_f32 v[144:145], v[104:105], v[34:35], v[32:33]
    v_pk_fma_f32 v[146:147], v[106:107], v[34:35], v[32:33]
    v_pk_fma_f32 v[148:149], v[108:109], v[34:35], v[32:33]
    v_pk_fma_f32 v[150:151], v[110:111], v[34:35], v[32:33]
    v_pk_fma_f32 v[136:137], v[136:137], v[44:45], v[52:53] op_sel:[0,0,0] op_sel_hi:[1,0,0]
    v_pk_fma_f32 v[138:139], v[138:139], v[44:45], v[52:53] op_sel:[0,1,1] op_sel_hi:[1,1,1]
    v_pk_fma_f32 v[140:141], v[140:141], v[46:47], v[54:55] op_sel:[0,0,0] op_sel_hi:[1,0,0]
    v_pk_fma_f32 v[142:143], v[142:143], v[46:47], v[54:55] op_sel:[0,1,1] op_sel_hi:[1,1,1]
    v_pk_fma_f32 v[144:145], v[144:145], v[48:49], v[56:57] op_sel:[0,0,0] op_sel_hi:[1,0,0]
    v_pk_fma_f32 v[146:147], v[146:147], v[48:49], v[56:57] op_sel:[0,1,1] op_sel_hi:[1,1,1]
    v_pk_fma_f32 v[148:149], v[148:149], v[50:51], v[58:59] op_sel:[0,0,0] op_sel_hi:[1,0,0]
    v_pk_fma_f32 v[150:151], v[150:151], v[50:51], v[58:59] op_sel:[0,1,1] op_sel_hi:[1,1,1]
    s_not_b32 s72, s72
    s_bfe_u32 s73, s72, 0x30001
    s_mov_b32 s70, 0x01010101
    s_mov_b32 s71, 0x01010101
    s_lshl_b64 s[70:71], s[70:71], s73
    s_bitcmp1_b32 s72, 0
    s_cbranch_scc1 L_h2odd
    v_cvt_pk_bf16_f32 v80, v136, v138
    v_cvt_pk_bf16_f32 v81, v140, v142
    v_cvt_pk_bf16_f32 v82, v144, v146
    v_cvt_pk_bf16_f32 v83, v148, v150
    s_branch L_h2st
L_h2odd:
    v_cvt_pk_bf16_f32 v80, v137, v139
    v_cvt_pk_bf16_f32 v81, v141, v143
    v_cvt_pk_bf16_f32 v82, v145, v147
    v_cvt_pk_bf16_f32 v83, v149, v151
L_h2st:
    s_mov_b64 exec, s[70:71]
    ds_write_b128 v9, v[80:83]
    s_mov_b64 exec, 0xffff
    ds_read_b128 v[84:87], v12
    s_waitcnt lgkmcnt(0)
    buffer_store_dwordx4 v[84:87], v10, s[16:19], s74 offen sc1
    s_mov_b64 exec, -1
    s_barrier
    v_pk_fma_f32 v[112:113], v[136:137], v[60:61], v[96:97] op_sel:[0,0,0] op_sel_hi:[1,0,1]
    v_pk_fma_f32 v[114:115], v[138:139], v[60:61], v[98:99] op_sel:[0,1,0] op_sel_hi:[1,1,1]
    v_pk_fma_f32 v[116:117], v[140:141], v[62:63], v[100:101] op_sel:[0,0,0] op_sel_hi:[1,0,1]
    v_pk_fma_f32 v[118:119], v[142:143], v[62:63], v[102:103] op_sel:[0,1,0] op_sel_hi:[1,1,1]
    v_pk_fma_f32 v[120:121], v[144:145], v[64:65], v[104:105] op_sel:[0,0,0] op_sel_hi:[1,0,1]
    v_pk_fma_f32 v[122:123], v[146:147], v[64:65], v[106:107] op_sel:[0,1,0] op_sel_hi:[1,1,1]
    v_pk_fma_f32 v[124:125], v[148:149], v[66:67], v[108:109] op_sel:[0,0,0] op_sel_hi:[1,0,1]
    v_pk_fma_f32 v[126:127], v[150:151], v[66:67], v[110:111] op_sel:[0,1,0] op_sel_hi:[1,1,1]
    v_cvt_pk_bf16_f32 v32, v112, v114
    v_cvt_pk_bf16_f32 v33, v116, v118
    v_cvt_pk_bf16_f32 v34, v120, v122
    v_cvt_pk_bf16_f32 v35, v124, v126
    v_cvt_pk_bf16_f32 v36, v113, v115
    v_cvt_pk_bf16_f32 v37, v117, v119
    v_cvt_pk_bf16_f32 v38, v121, v123
    v_cvt_pk_bf16_f32 v39, v125, v127
    ds_write_b128 v18, v[32:35]
    ds_write_b128 v18, v[36:39] offset:1312
    ds_read_b128 v[128:131], v27
    ds_read_b128 v[132:135], v27 offset:10496
    s_waitcnt lgkmcnt(1)
    buffer_store_dwordx4 v[128:131], v28, s[24:27], s76 offen sc1
    s_waitcnt lgkmcnt(0)
    buffer_store_dwordx4 v[132:135], v28, s[24:27], s77 offen sc1
    s_mov_b64 exec, s[70:71]
    s_bitcmp1_b32 s72, 0
    s_cbranch_scc1 L_bodd
    ds_write2_b32 v25, v112, v114 offset0:0 offset1:1
    ds_write2_b32 v25, v116, v118 offset0:2 offset1:3
    ds_write2_b32 v25, v120, v122 offset0:4 offset1:5
    ds_write2_b32 v25, v124, v126 offset0:6 offset1:7
    s_branch L_bst
L_bodd:
    ds_write2_b32 v25, v113, v115 offset0:0 offset1:1
    ds_write2_b32 v25, v117, v119 offset0:2 offset1:3
    ds_write2_b32 v25, v121, v123 offset0:4 offset1:5
    ds_write2_b32 v25, v125, v127 offset0:6 offset1:7
L_bst:
    s_mov_b32 exec_lo, -1
    s_mov_b32 exec_hi, 0
    v_mov_b32 v89, v167
    v_mov_b32 v91, v167
    ds_read_b32 v88, v26
    ds_read_b32 v90, v26 offset:4
    s_waitcnt vmcnt(0) lgkmcnt(0)
    buffer_store_dwordx4 v[88:91], v11, s[16:19], s75 offen sc1
    s_mov_b64 exec, -1
    s_branch L_end
L_helper:
    s_cmp_lg_u32 s61, 4
    s_cbranch_scc1 L_hq
    s_lshl_b32 s82, s3, 7
    s_add_u32 s82, s82, 1703936
    v_mov_b32 v44, v167
    v_mov_b32 v45, v167
    v_mov_b32 v46, v167
    v_mov_b32 v47, v167
    buffer_store_dwordx4 v[44:47], v17, s[16:19], s82 offen sc1
L_hq:
    s_cmp_ge_u32 s61, 6
    s_cbranch_scc1 L_hq1
    s_lshr_b32 s82, s2, 3
    s_lshl1_add_u32 s82, s82, s61
    s_add_u32 s82, s82, 28
    s_mul_i32 s82, s82, 61440
    s_and_b32 s83, s2, 7
    s_lshl_b32 s83, s83, 7
    s_add_u32 s82, s82, s83
    v_lshlrev_b32 v165, 10, v5
    s_mov_b32 s83, 7680
    v_mad_u32_u24 v165, v4, s83, v165
    buffer_load_dword v163, v165, s[52:55], s82 offen
L_hq1:
    v_subrev_u32 v40, 320, v0
    v_lshlrev_b32 v41, 2, v40
    buffer_load_dword v76, v41, s[32:35], 0 offen
    v_lshlrev_b32 v48, 4, v3
    s_mov_b32 s83, 1280
    v_mad_u32_u24 v49, v2, s83, v48
    v_mov_b32 v50, 0x7ffffff0
    s_cmp_lt_u32 s2, 128
    s_cselect_b64 vcc, -1, 0
    s_sub_u32 s74, s61, 6
    s_cselect_b64 vcc, 0, vcc
    s_and_b32 s74, s74, 3
    s_lshl2_add_u32 s72, s59, s74
    s_mul_i32 s72, s72, 5120
    s_cbranch_vccz L_hq2
    buffer_load_dwordx4 v[120:123], v49, s[28:31], s72 offen offset:0
    buffer_load_dwordx4 v[124:127], v49, s[28:31], s72 offen offset:256
    buffer_load_dwordx4 v[128:131], v49, s[28:31], s72 offen offset:512
    buffer_load_dwordx4 v[132:135], v49, s[28:31], s72 offen offset:768
    buffer_load_dwordx4 v[136:139], v49, s[28:31], s72 offen offset:1024
    s_cmp_lt_u32 s61, 8
    s_cbranch_scc1 L_hmod
    s_branch L_hmod
L_hq2:
    s_cmp_lt_u32 s2, 128
    s_cbranch_scc1 L_hrow
    s_and_b32 s70, s2, 7
    s_lshr_b32 s71, s2, 3
    s_mul_i32 s71, s71, 6
    s_add_u32 s71, s71, s61
    s_sub_u32 s71, s71, 100
    s_bitcmp1_b32 s71, 0
    s_cselect_b64 s[36:37], s[40:41], s[36:37]
    v_mul_u32_u24 v41, 3456, v1
    s_lshr_b32 s72, s71, 1
    s_mul_i32 s72, s72, 221184
    s_lshl_b32 s73, s70, 7
    s_add_u32 s72, s72, s73
    s_cmp_ge_u32 s71, 20
    s_cbranch_scc1 L_g1_11
    buffer_load_dword v163, v41, s[36:39], s72 offen
L_g1_11:
    s_cmp_ge_u32 s70, 4
    s_cbranch_scc1 L_g2_12
    s_cmp_lt_u32 s71, 14
    s_cbranch_scc1 L_g2_12
    s_sub_u32 s72, s72, 1547264
    buffer_load_dword v163, v41, s[36:39], s72 offen
L_g2_12:
    s_cmp_ge_u32 s61, 8
    s_cbranch_scc1 L_end
    s_add_u32 s81, s80, 4096
    s_mov_b64 exec, 1
    ds_read_b32 v60, v30 offset:4
    s_mov_b32 s72, 4
    s_mov_b32 s79, 0
L_ze0_13:
    s_waitcnt lgkmcnt(0)
    v_cmp_eq_u32 vcc, s72, v60
    s_cbranch_vccnz L_ze0_done_14
    s_sleep 3
    ds_read_b32 v60, v30 offset:4
    s_mov_b32 s72, 4
    s_add_u32 s79, s79, 1
    s_cmp_gt_u32 s79, 8388608
    s_cbranch_scc0 L_ze0_13
L_ze0_done_14:
    s_mov_b64 exec, -1
    ds_read2st64_b32 v[80:81], v15 offset0:0 offset1:20
    ds_read2st64_b32 v[82:83], v15 offset0:40 offset1:60
    ds_read2st64_b32 v[84:85], v16 offset0:0 offset1:20
    ds_read2st64_b32 v[86:87], v16 offset0:40 offset1:60
    s_waitcnt lgkmcnt(2)
    buffer_store_dwordx4 v[80:83], v11, s[16:19], s80 offen offset:0 sc1
    s_waitcnt lgkmcnt(0)
    buffer_store_dwordx4 v[84:87], v11, s[16:19], s80 offen offset:1024 sc1
    s_branch L_end
L_hrow:
    s_cmp_lg_u32 s61, 4
    s_cbranch_scc1 L_hmod
    s_lshr_b32 s73, s59, 2
    s_mul_i32 s73, s73, 8192
    s_mul_i32 s72, s59, 2048
    s_add_u32 s72, s72, s73
    s_add_u32 s72, s72, 6815744
    s_add_u32 s73, s72, 8192
    buffer_store_dwordx4 v[44:47], v11, s[16:19], s72 offen sc1
    buffer_store_dword v44, v164, s[16:19], s72 offen offset:1024 sc1
    buffer_store_dwordx4 v[44:47], v11, s[16:19], s73 offen sc1
    buffer_store_dword v44, v164, s[16:19], s73 offen offset:1024 sc1
    s_and_b32 s72, s2, 7
    s_mul_i32 s72, s72, 20480
    s_add_u32 s72, s72, 1703936
    s_add_u32 s73, s72, 8192
    s_add_u32 s74, s72, 12288
    v_lshlrev_b32 v40, 7, v1
    s_mov_b32 s78, s72
    s_add_u32 s81, s80, 4096
    s_mov_b64 exec, 1
    ds_read_b32 v60, v30 offset:4
    s_mov_b32 s72, 4
    s_mov_b32 s79, 0
L_ze1_15:
    s_waitcnt lgkmcnt(0)
    v_cmp_eq_u32 vcc, s72, v60
    s_cbranch_vccnz L_ze1_done_16
    s_sleep 3
    ds_read_b32 v60, v30 offset:4
    s_mov_b32 s72, 4
    s_add_u32 s79, s79, 1
    s_cmp_gt_u32 s79, 8388608
    s_cbranch_scc0 L_ze1_15
L_ze1_done_16:
    s_mov_b64 exec, -1
    ds_read2st64_b32 v[80:81], v15 offset0:0 offset1:20
    ds_read2st64_b32 v[82:83], v15 offset0:40 offset1:60
    ds_read2st64_b32 v[84:85], v16 offset0:0 offset1:20
    ds_read2st64_b32 v[86:87], v16 offset0:40 offset1:60
    s_waitcnt lgkmcnt(2)
    buffer_store_dwordx4 v[80:83], v11, s[16:19], s80 offen offset:0 sc1
    s_waitcnt lgkmcnt(0)
    buffer_store_dwordx4 v[84:87], v11, s[16:19], s80 offen offset:1024 sc1
    s_mov_b32 s72, s78
    s_mov_b32 s79, 0
L_clr_17:
    s_sleep 2
    buffer_load_dword v41, v40, s[16:19], s72 offen sc1
    buffer_load_dword v42, v40, s[16:19], s73 offen sc1
    buffer_load_dword v43, v40, s[16:19], s74 offen sc1
    s_add_u32 s79, s79, 1
    s_cmp_gt_u32 s79, 524288
    s_cbranch_scc1 L_clr_done_18
    s_waitcnt vmcnt(0)
    v_cmp_ne_u32 vcc, s60, v41
    v_cmp_ne_u32 s[70:71], s60, v42
    s_or_b64 s[70:71], s[70:71], vcc
    v_cmp_ne_u32 vcc, s60, v43
    s_or_b64 exec, s[70:71], vcc
    s_cbranch_scc1 L_clr_17
L_clr_done_18:
    s_mov_b64 exec, -1
    s_branch L_zjoin2
L_hmod:
    s_mov_b32 s69, s74
    v_subrev_u32 v40, 320, v0
    v_lshlrev_b32 v41, 2, v40
    v_lshlrev_b32 v41, 3, v40
    v_add_u32 v42, 141696, v41
    s_and_b32 s72, s2, 7
    s_mul_i32 s72, s72, 16384
    v_add_u32 v41, s72, v41
    s_mov_b32 s72, 1376256
    s_mov_b32 s73, 1381376
    s_mov_b32 s74, 1386496
    s_cmp_eq_u32 s61, 5
    s_cbranch_scc1 L_noqs
    s_cmp_ge_u32 s61, 8
    s_waitcnt vmcnt(0)
    s_cbranch_scc1 L_qgo
    s_waitcnt vmcnt(0)
L_qgo:
    s_mul_i32 s70, s69, 5248
    s_add_u32 s70, s70, 120704
    s_mov_b32 s83, 1312
    v_mad_u32_u24 v52, v2, s83, v48
    v_add_u32 v52, s70, v52
    s_lshl_b32 s70, s69, 5
    s_add_u32 s70, s70, 159616
    v_bfe_u32 v43, v0, 5, 1
    v_lshl_add_u32 v43, v43, 4, s70
    v_bfe_u32 v44, v0, 4, 1
    v_lshl_add_u32 v43, v44, 2, v43
    ds_write_b128 v52, v[120:123] offset:0
    ds_write_b128 v52, v[124:127] offset:256
    ds_write_b128 v52, v[128:131] offset:512
    ds_write_b128 v52, v[132:135] offset:768
    ds_write_b128 v52, v[136:139] offset:1024
    v_lshlrev_b32 v50, 16, v120
    v_and_b32 v51, v29, v120
    v_add_f32 v44, v50, v51
    v_mul_f32 v46, v50, v50
    v_fmac_f32 v46, v51, v51
    v_lshlrev_b32 v50, 16, v121
    v_and_b32 v51, v29, v121
    v_add_f32 v44, v44, v50
    v_fmac_f32 v46, v50, v50
    v_add_f32 v44, v44, v51
    v_fmac_f32 v46, v51, v51
    v_lshlrev_b32 v50, 16, v122
    v_and_b32 v51, v29, v122
    v_add_f32 v44, v44, v50
    v_fmac_f32 v46, v50, v50
    v_add_f32 v44, v44, v51
    v_fmac_f32 v46, v51, v51
    v_lshlrev_b32 v50, 16, v123
    v_and_b32 v51, v29, v123
    v_add_f32 v44, v44, v50
    v_fmac_f32 v46, v50, v50
    v_add_f32 v44, v44, v51
    v_fmac_f32 v46, v51, v51
    v_lshlrev_b32 v50, 16, v124
    v_and_b32 v51, v29, v124
    v_add_f32 v44, v44, v50
    v_fmac_f32 v46, v50, v50
    v_add_f32 v44, v44, v51
    v_fmac_f32 v46, v51, v51
    v_lshlrev_b32 v50, 16, v125
    v_and_b32 v51, v29, v125
    v_add_f32 v44, v44, v50
    v_fmac_f32 v46, v50, v50
    v_add_f32 v44, v44, v51
    v_fmac_f32 v46, v51, v51
    v_lshlrev_b32 v50, 16, v126
    v_and_b32 v51, v29, v126
    v_add_f32 v44, v44, v50
    v_fmac_f32 v46, v50, v50
    v_add_f32 v44, v44, v51
    v_fmac_f32 v46, v51, v51
    v_lshlrev_b32 v50, 16, v127
    v_and_b32 v51, v29, v127
    v_add_f32 v44, v44, v50
    v_fmac_f32 v46, v50, v50
    v_add_f32 v44, v44, v51
    v_fmac_f32 v46, v51, v51
    v_lshlrev_b32 v50, 16, v128
    v_and_b32 v51, v29, v128
    v_add_f32 v44, v44, v50
    v_fmac_f32 v46, v50, v50
    v_add_f32 v44, v44, v51
    v_fmac_f32 v46, v51, v51
    s_cmp_lt_u32 s61, 8
    s_cbranch_scc1 L_nomid
    buffer_load_dwordx2 v[64:65], v41, s[16:19], s72 offen offset:0 sc1
    buffer_load_dwordx2 v[66:67], v41, s[16:19], s72 offen offset:2560 sc1
    buffer_load_dwordx2 v[68:69], v41, s[16:19], s73 offen offset:0 sc1
    buffer_load_dwordx2 v[70:71], v41, s[16:19], s73 offen offset:2560 sc1
    buffer_load_dwordx2 v[72:73], v41, s[16:19], s74 offen offset:0 sc1
    buffer_load_dwordx2 v[74:75], v41, s[16:19], s74 offen offset:2560 sc1
L_nomid:
    v_lshlrev_b32 v50, 16, v129
    v_and_b32 v51, v29, v129
    v_add_f32 v44, v44, v50
    v_fmac_f32 v46, v50, v50
    v_add_f32 v44, v44, v51
    v_fmac_f32 v46, v51, v51
    v_lshlrev_b32 v50, 16, v130
    v_and_b32 v51, v29, v130
    v_add_f32 v44, v44, v50
    v_fmac_f32 v46, v50, v50
    v_add_f32 v44, v44, v51
    v_fmac_f32 v46, v51, v51
    v_lshlrev_b32 v50, 16, v131
    v_and_b32 v51, v29, v131
    v_add_f32 v44, v44, v50
    v_fmac_f32 v46, v50, v50
    v_add_f32 v44, v44, v51
    v_fmac_f32 v46, v51, v51
    v_lshlrev_b32 v50, 16, v132
    v_and_b32 v51, v29, v132
    v_add_f32 v44, v44, v50
    v_fmac_f32 v46, v50, v50
    v_add_f32 v44, v44, v51
    v_fmac_f32 v46, v51, v51
    v_lshlrev_b32 v50, 16, v133
    v_and_b32 v51, v29, v133
    v_add_f32 v44, v44, v50
    v_fmac_f32 v46, v50, v50
    v_add_f32 v44, v44, v51
    v_fmac_f32 v46, v51, v51
    v_lshlrev_b32 v50, 16, v134
    v_and_b32 v51, v29, v134
    v_add_f32 v44, v44, v50
    v_fmac_f32 v46, v50, v50
    v_add_f32 v44, v44, v51
    v_fmac_f32 v46, v51, v51
    v_lshlrev_b32 v50, 16, v135
    v_and_b32 v51, v29, v135
    v_add_f32 v44, v44, v50
    v_fmac_f32 v46, v50, v50
    v_add_f32 v44, v44, v51
    v_fmac_f32 v46, v51, v51
    v_lshlrev_b32 v50, 16, v136
    v_and_b32 v51, v29, v136
    v_add_f32 v44, v44, v50
    v_fmac_f32 v46, v50, v50
    v_add_f32 v44, v44, v51
    v_fmac_f32 v46, v51, v51
    v_lshlrev_b32 v50, 16, v137
    v_and_b32 v51, v29, v137
    v_add_f32 v44, v44, v50
    v_fmac_f32 v46, v50, v50
    v_add_f32 v44, v44, v51
    v_fmac_f32 v46, v51, v51
    v_lshlrev_b32 v50, 16, v138
    v_and_b32 v51, v29, v138
    v_add_f32 v44, v44, v50
    v_fmac_f32 v46, v50, v50
    v_add_f32 v44, v44, v51
    v_fmac_f32 v46, v51, v51
    v_lshlrev_b32 v50, 16, v139
    v_and_b32 v51, v29, v139
    v_add_f32 v44, v44, v50
    v_fmac_f32 v46, v50, v50
    v_add_f32 v44, v44, v51
    v_fmac_f32 v46, v51, v51
    s_nop 0
    v_add_f32_dpp v44, v44, v44 row_ror:1 row_mask:0xf bank_mask:0xf
    v_add_f32_dpp v46, v46, v46 row_ror:1 row_mask:0xf bank_mask:0xf
    s_nop 0
    v_add_f32_dpp v44, v44, v44 row_ror:2 row_mask:0xf bank_mask:0xf
    v_add_f32_dpp v46, v46, v46 row_ror:2 row_mask:0xf bank_mask:0xf
    s_nop 0
    v_add_f32_dpp v44, v44, v44 row_ror:4 row_mask:0xf bank_mask:0xf
    v_add_f32_dpp v46, v46, v46 row_ror:4 row_mask:0xf bank_mask:0xf
    s_nop 0
    v_add_f32_dpp v44, v44, v44 row_ror:8 row_mask:0xf bank_mask:0xf
    v_add_f32_dpp v46, v46, v46 row_ror:8 row_mask:0xf bank_mask:0xf
    v_mul_f32 v44, 0xbacccccd, v44
    v_mul_f32 v46, 0x3acccccd, v46
    v_fma_f32 v46, -v44, v44, v46
    v_max_f32 v46, 0, v46
    v_add_f32 v46, 0x3727c5ac, v46
    v_rsq_f32 v46, v46
    s_nop 0
    v_mul_f32 v44, v44, v46
    ds_write2_b32 v43, v46, v44 offset0:0 offset1:2
L_noqs:
    s_cmp_ge_u32 s61, 8
    s_cbranch_scc1 L_modwait
    s_mov_b64 exec, 1
    ds_read_b32 v60, v30 offset:4
    s_mov_b32 s72, 4
    s_mov_b32 s79, 0
L_mp_19:
    s_waitcnt lgkmcnt(0)
    v_cmp_eq_u32 vcc, s72, v60
    s_cbranch_vccnz L_mp_done_20
    s_sleep 3
    ds_read_b32 v60, v30 offset:4
    s_mov_b32 s72, 4
    s_add_u32 s79, s79, 1
    s_cmp_gt_u32 s79, 8388608
    s_cbranch_scc0 L_mp_19
L_mp_done_20:
    s_mov_b64 exec, -1
    s_mov_b32 s72, 1376256
    buffer_load_dwordx2 v[64:65], v41, s[16:19], s72 offen offset:0 sc1
    buffer_load_dwordx2 v[66:67], v41, s[16:19], s72 offen offset:2560 sc1
    buffer_load_dwordx2 v[68:69], v41, s[16:19], s73 offen offset:0 sc1
    buffer_load_dwordx2 v[70:71], v41, s[16:19], s73 offen offset:2560 sc1
    buffer_load_dwordx2 v[72:73], v41, s[16:19], s74 offen offset:0 sc1
    buffer_load_dwordx2 v[74:75], v41, s[16:19], s74 offen offset:2560 sc1
    ds_read2st64_b32 v[96:97], v15 offset0:0 offset1:20
    ds_read2st64_b32 v[98:99], v15 offset0:40 offset1:60
    ds_read2st64_b32 v[100:101], v16 offset0:0 offset1:20
    ds_read2st64_b32 v[102:103], v16 offset0:40 offset1:60
    s_waitcnt lgkmcnt(2)
    buffer_store_dwordx4 v[96:99], v11, s[16:19], s80 offen offset:0 sc1
    s_waitcnt lgkmcnt(0)
    buffer_store_dwordx4 v[100:103], v11, s[16:19], s80 offen offset:1024 sc1
    s_mov_b32 s79, 0
    s_waitcnt vmcnt(2)
    s_branch L_modchk
L_modwait:
    s_mov_b32 s79, 0
L_mod_23:
    s_waitcnt vmcnt(0)
L_modchk:
    v_xor_b32 v65, s60, v65
    v_xor_b32 v67, s60, v67
    v_xor_b32 v69, s60, v69
    v_xor_b32 v71, s60, v71
    v_xor_b32 v73, s60, v73
    v_xor_b32 v75, s60, v75
    v_or3_b32 v65, v65, v67, v69
    v_or3_b32 v71, v71, v73, v75
    v_or_b32 v65, v65, v71
    v_cmp_ne_u32 vcc, 0, v65
    s_cbranch_vccz L_mod_done_24
    buffer_load_dwordx2 v[64:65], v41, s[16:19], s72 offen offset:0 sc1
    buffer_load_dwordx2 v[66:67], v41, s[16:19], s72 offen offset:2560 sc1
    buffer_load_dwordx2 v[68:69], v41, s[16:19], s73 offen offset:0 sc1
    buffer_load_dwordx2 v[70:71], v41, s[16:19], s73 offen offset:2560 sc1
    buffer_load_dwordx2 v[72:73], v41, s[16:19], s74 offen offset:0 sc1
    buffer_load_dwordx2 v[74:75], v41, s[16:19], s74 offen offset:2560 sc1
    s_add_u32 s79, s79, 1
    s_cmp_gt_u32 s79, 524288
    s_cbranch_scc0 L_mod_23
    s_waitcnt vmcnt(0)
L_mod_done_24:
    v_lshlrev_b32 v80, 16, v64
    v_and_b32 v81, v29, v64
    v_lshlrev_b32 v82, 16, v66
    v_and_b32 v83, v29, v66
    v_lshlrev_b32 v84, 16, v68
    v_and_b32 v85, v29, v68
    v_lshlrev_b32 v86, 16, v70
    v_and_b32 v87, v29, v70
    v_lshlrev_b32 v88, 16, v72
    v_and_b32 v89, v29, v72
    v_lshlrev_b32 v90, 16, v74
    v_and_b32 v91, v29, v74
    v_lshlrev_b32 v92, 16, v76
    v_and_b32 v93, v29, v76
    v_add_f32 v82, 1.0, v82
    v_cvt_pk_bf16_f32 v82, 0, v82
    v_add_f32 v83, 1.0, v83
    v_cvt_pk_bf16_f32 v83, 0, v83
    v_add_f32 v88, 1.0, v88
    v_cvt_pk_bf16_f32 v88, 0, v88
    v_add_f32 v89, 1.0, v89
    v_cvt_pk_bf16_f32 v89, 0, v89
    v_mul_f32 v82, v82, v84
    v_mul_f32 v80, v80, v84
    v_mul_f32 v94, v86, v92
    v_mul_f32 v92, v88, v92
    v_mul_f32 v83, v83, v85
    v_mul_f32 v81, v81, v85
    v_mul_f32 v95, v87, v93
    v_mul_f32 v93, v89, v93
    v_add_f32 v44, v92, v93
    v_mul_f32 v92, 0x44200000, v92
    v_mul_f32 v93, 0x44200000, v93
    ds_write_b64 v42, v[82:83] offset:0
    ds_write_b64 v42, v[80:81] offset:2560
    ds_write_b64 v42, v[88:89] offset:5120
    ds_write_b64 v42, v[86:87] offset:7680
    ds_write_b64 v42, v[90:91] offset:10240
    ds_write_b64 v42, v[92:93] offset:12800
    v_add_f32 v46, v94, v95
    v_add_f32_dpp v44, v44, v44 row_ror:1 row_mask:0xf bank_mask:0xf
    s_nop 0
    v_add_f32_dpp v46, v46, v46 row_ror:1 row_mask:0xf bank_mask:0xf
    v_add_f32_dpp v44, v44, v44 row_ror:2 row_mask:0xf bank_mask:0xf
    s_nop 0
    v_add_f32_dpp v46, v46, v46 row_ror:2 row_mask:0xf bank_mask:0xf
    v_add_f32_dpp v44, v44, v44 row_ror:4 row_mask:0xf bank_mask:0xf
    s_nop 0
    v_add_f32_dpp v46, v46, v46 row_ror:4 row_mask:0xf bank_mask:0xf
    v_add_f32_dpp v44, v44, v44 row_ror:8 row_mask:0xf bank_mask:0xf
    s_nop 0
    v_add_f32_dpp v46, v46, v46 row_ror:8 row_mask:0xf bank_mask:0xf
    v_cvt_f64_f32 v[44:45], v44
    v_cvt_f64_f32 v[46:47], v46
    v_mov_b32 v42, 157440
    s_mov_b32 exec_lo, 0x00010001
    s_mov_b32 exec_hi, 0x00010001
    ds_add_f64 v42, v[44:45]
    ds_add_f64 v42, v[46:47] offset:8
    s_mov_b64 exec, -1
    s_branch L_zjoin2
L_locate:
    s_mov_b32 s70, 8224768
    s_mov_b32 s71, 8232960
    s_mov_b32 s78, 8257536
    s_mov_b32 s83, 1024
    v_mad_u32_u24 v12, v4, s83, v6
    v_mov_b32 v16, 1
    v_mov_b32 v17, 1
    v_mov_b32 v18, 1
    v_mov_b32 v19, 1
    buffer_store_dwordx4 v[16:19], v12, s[16:19], s70 offen sc1
    buffer_store_dwordx4 v[16:19], v12, s[16:19], s71 offen sc1
    s_waitcnt lgkmcnt(0)
    s_mul_i32 s60, s60, 0x9e3779b1
    s_add_u32 s60, s60, 0x7f4a7c15
    s_and_b32 s60, s60, 0x1fffff
    s_or_b32 s60, s60, 0x7fa00000
    s_add_u32 s70, s70, 4
    s_mov_b32 s74, 0
    s_movk_i32 s76, 0x1000
    s_movk_i32 s77, 0x1000
    s_waitcnt vmcnt(0)
L_round:
    s_mov_b32 s75, 0
    s_movk_i32 s72, -4096
    s_load_dword s75, s[16:17], s70 glc
L_count0:
    s_add_u32 s72, s72, 1
    s_addc_u32 s73, s75, 0
    s_cmp_eq_u32 s73, 0
    s_cbranch_scc1 L_count0
    s_and_b32 s72, s72, 0xfff
    s_waitcnt lgkmcnt(0)
    s_min_u32 s76, s76, s72
    s_xor_b32 s70, s70, 8192
    s_mov_b32 s75, 0
    s_movk_i32 s72, -4096
    s_load_dword s75, s[16:17], s70 glc
L_count1:
    s_add_u32 s72, s72, 1
    s_addc_u32 s73, s75, 0
    s_cmp_eq_u32 s73, 0
    s_cbranch_scc1 L_count1
    s_and_b32 s72, s72, 0xfff
    s_waitcnt lgkmcnt(0)
    s_min_u32 s77, s77, s72
    s_xor_b32 s70, s70, 8192
    s_add_u32 s70, s70, 1024
    s_add_u32 s74, s74, 1
    s_cmp_lt_u32 s74, 4
    s_cbranch_scc1 L_round
    s_getreg_b32 s72, hwreg(HW_REG_XCC_ID, 2, 1)
    s_cmp_lt_u32 s77, s76
    s_addc_u32 s72, s72, 0
    v_mov_b32 v16, s72
    v_mov_b32 v17, s60
    s_mov_b64 exec, 0xff
    buffer_store_dwordx4 v[16:19], v11, s[16:19], s78 offen sc1
    s_branch L_end
L_nonconv:
    s_mov_b32 s64, 0x05040100
    s_mov_b32 s65, 0x07060302
    v_lshlrev_b32 v131, 3, v3
    v_lshlrev_b32 v132, 2, v3
    v_mov_b32 v157, v167
    v_mov_b32 v159, v167
    v_bfe_u32 v137, v0, 5, 1
    v_and_b32 v130, 31, v0
    v_lshlrev_b32 v130, 2, v130
    s_mov_b32 s83, 138240
    v_mad_u32_u24 v134, v2, s83, v132
    s_mov_b32 s83, 20480
    v_mad_u32_u24 v135, v137, s83, v130
    v_lshl_add_u32 v136, v137, 6, v132
    s_sub_u32 s70, s2, 160
    s_max_u32 s68, s2, 200
    s_sub_u32 s68, s68, 200
    s_and_b32 s73, s68, 7
    s_bfe_u32 s74, s68, 0x10003
    s_lshl_b32 s73, s73, 1
    s_add_u32 s73, s73, s74
    s_and_b32 s74, s68, 0x30
    s_add_u32 s73, s73, s74
    s_cmp_lt_u32 s68, 48
    s_cselect_b32 s68, s73, s68
    s_sub_u32 s69, 7, s61
    s_bitcmp1_b32 s68, 0
    s_cselect_b32 s69, s69, s61
    s_and_b32 s69, s69, 7
    s_bitcmp1_b32 s69, 0
    s_cselect_b64 s[36:37], s[40:41], s[36:37]
    s_lshr_b32 s71, s69, 1
    s_mul_i32 s74, s71, 552960
    s_lshl_b32 s73, s68, 6
    s_add_u32 s74, s74, s73
    s_mul_i32 s76, s68, 40960
    s_lshl_b32 s73, s61, 7
    s_add_u32 s76, s76, s73
    s_and_b32 s82, s69, 1
    s_lshl_b32 s82, s82, 3
    s_add_u32 s82, s82, 157568
    v_lshl_add_u32 v129, v3, 5, s82
    v_lshl_add_u32 v154, v137, 4, v129
    v_lshlrev_b32 v129, 2, v136
    v_add_u32 v155, 157568, v129
    s_mul_i32 s82, s71, 320
    s_add_u32 s82, s82, 6815744
    v_min_u32 v129, 72, v131
    v_add_u32 v129, s82, v129
    s_mov_b32 s83, 80
    v_mad_u32_u24 v160, v2, s83, v129
    s_mul_i32 s82, s68, 16384
    s_lshl_b32 s73, s61, 9
    s_add_u32 s82, s82, s73
    s_add_u32 s81, s82, 7340032
    s_mov_b32 s83, 7680
    v_mad_u32_u24 v162, v137, s83, v11
    s_mov_b32 s78, s60
    s_cmp_lt_u32 s2, 224
    s_cbranch_scc1 L_nowm
    s_cmp_lt_u32 s61, 8
    s_cbranch_scc1 L_nowm
    s_lshr_b32 s82, s2, 3
    s_lshl1_add_u32 s82, s82, s61
    s_add_u32 s82, s82, 8
    s_mul_i32 s82, s82, 61440
    s_and_b32 s83, s2, 7
    s_lshl_b32 s83, s83, 7
    s_add_u32 s82, s82, s83
    v_lshlrev_b32 v165, 10, v5
    s_mov_b32 s83, 7680
    v_mad_u32_u24 v165, v4, s83, v165
    buffer_load_dword v163, v165, s[52:55], s82 offen
L_nowm:
    s_cmp_ge_u32 s2, 254
    s_cbranch_scc1 L_end
    s_barrier
    s_cmp_ge_u32 s2, 220
    s_cbranch_scc1 L_mlp
    s_cmp_lg_u32 s61, 0
    s_cbranch_scc1 L_nowarm
    v_lshlrev_b32 v139, 4, v3
    s_mov_b32 s83, 16384
    v_mad_u32_u24 v139, v2, s83, v139
    s_lshl_b32 s72, s70, 8
    s_add_u32 s72, s72, 1376256
    s_add_u32 s73, s72, 65536
    v_mov_b32 v144, 0
    v_mov_b32 v145, 0
    v_mov_b32 v146, 0
    v_mov_b32 v147, 0
    buffer_store_dwordx4 v[144:147], v139, s[16:19], s72 offen sc1
    buffer_store_dwordx4 v[144:147], v139, s[16:19], s73 offen sc1
L_nowarm:
    v_bfe_u32 v137, v0, 5, 1
    v_and_b32 v130, 31, v0
    v_lshlrev_b32 v130, 2, v130
    s_mov_b32 s83, 245760
    v_mad_u32_u24 v133, v137, s83, v130
    v_lshlrev_b32 v132, 2, v3
    v_lshl_add_u32 v136, v137, 6, v132
    s_sub_u32 s73, s2, 160
    s_lshl_b32 s73, s73, 7
    s_mul_i32 s72, s61, 491520
    s_add_u32 s72, s72, s73
    s_lshl_b32 s73, s61, 7
    buffer_load_dword v138, v136, s[48:51], s73 offen
    buffer_load_dword v96, v133, s[52:55], s72 offen
    s_add_u32 s72, s72, 7680
    buffer_load_dword v97, v133, s[52:55], s72 offen
    s_add_u32 s72, s72, 7680
    buffer_load_dword v98, v133, s[52:55], s72 offen
    s_add_u32 s72, s72, 7680
    buffer_load_dword v99, v133, s[52:55], s72 offen
    s_add_u32 s72, s72, 7680
    buffer_load_dword v100, v133, s[52:55], s72 offen
    s_add_u32 s72, s72, 7680
    buffer_load_dword v101, v133, s[52:55], s72 offen
    s_add_u32 s72, s72, 7680
    buffer_load_dword v102, v133, s[52:55], s72 offen
    s_add_u32 s72, s72, 7680
    buffer_load_dword v103, v133, s[52:55], s72 offen
    s_add_u32 s72, s72, 7680
    buffer_load_dword v104, v133, s[52:55], s72 offen
    s_add_u32 s72, s72, 7680
    buffer_load_dword v105, v133, s[52:55], s72 offen
    s_add_u32 s72, s72, 7680
    buffer_load_dword v106, v133, s[52:55], s72 offen
    s_add_u32 s72, s72, 7680
    buffer_load_dword v107, v133, s[52:55], s72 offen
    s_add_u32 s72, s72, 7680
    buffer_load_dword v108, v133, s[52:55], s72 offen
    s_add_u32 s72, s72, 7680
    buffer_load_dword v109, v133, s[52:55], s72 offen
    s_add_u32 s72, s72, 7680
    buffer_load_dword v110, v133, s[52:55], s72 offen
    s_add_u32 s72, s72, 7680
    buffer_load_dword v111, v133, s[52:55], s72 offen
    s_add_u32 s72, s72, 7680
    buffer_load_dword v112, v133, s[52:55], s72 offen
    s_add_u32 s72, s72, 7680
    buffer_load_dword v113, v133, s[52:55], s72 offen
    s_add_u32 s72, s72, 7680
    buffer_load_dword v114, v133, s[52:55], s72 offen
    s_add_u32 s72, s72, 7680
    buffer_load_dword v115, v133, s[52:55], s72 offen
    s_add_u32 s72, s72, 7680
    buffer_load_dword v116, v133, s[52:55], s72 offen
    s_add_u32 s72, s72, 7680
    buffer_load_dword v117, v133, s[52:55], s72 offen
    s_add_u32 s72, s72, 7680
    buffer_load_dword v118, v133, s[52:55], s72 offen
    s_add_u32 s72, s72, 7680
    buffer_load_dword v119, v133, s[52:55], s72 offen
    s_add_u32 s72, s72, 7680
    buffer_load_dword v120, v133, s[52:55], s72 offen
    s_add_u32 s72, s72, 7680
    buffer_load_dword v121, v133, s[52:55], s72 offen
    s_add_u32 s72, s72, 7680
    buffer_load_dword v122, v133, s[52:55], s72 offen
    s_add_u32 s72, s72, 7680
    buffer_load_dword v123, v133, s[52:55], s72 offen
    s_add_u32 s72, s72, 7680
    buffer_load_dword v124, v133, s[52:55], s72 offen
    s_add_u32 s72, s72, 7680
    buffer_load_dword v125, v133, s[52:55], s72 offen
    s_add_u32 s72, s72, 7680
    buffer_load_dword v126, v133, s[52:55], s72 offen
    s_add_u32 s72, s72, 7680
    buffer_load_dword v127, v133, s[52:55], s72 offen
L_modgo:
    s_waitcnt vmcnt(32)
    v_lshlrev_b32 v139, 16, v138
    v_and_b32 v138, v29, v138
    v_mul_f32 v140, 0xbfb8aa3b, v139
    v_exp_f32 v140, v140
    s_nop 0
    v_add_f32 v140, 1.0, v140
    v_rcp_f32 v140, v140
    s_nop 0
    v_mul_f32 v139, v139, v140
    v_mul_f32 v141, 0xbfb8aa3b, v138
    v_exp_f32 v141, v141
    s_nop 0
    v_add_f32 v141, 1.0, v141
    v_rcp_f32 v141, v141
    s_nop 0
    v_mul_f32 v138, v138, v141
    v_cvt_pk_bf16_f32 v138, v139, v138
    v_mov_b32 v140, 0
    v_mov_b32 v141, 0
    v_mov_b32 v142, 0
    v_mov_b32 v143, 0
    v_lshl_add_u32 v129, v130, 2, 0
    v_lshl_add_u32 v129, v137, 3, v129
    v_add_u32 v129, 158080, v129
    s_waitcnt vmcnt(30)
    v_perm_b32 v60, v97, v96, s64
    v_perm_b32 v61, v97, v96, s65
    s_waitcnt vmcnt(28)
    v_perm_b32 v62, v99, v98, s64
    v_perm_b32 v63, v99, v98, s65
    v_dot2c_f32_bf16_dpp v140, v138, v60 row_newbcast:0 row_mask:0xf bank_mask:0xf
    v_dot2c_f32_bf16_dpp v141, v138, v61 row_newbcast:0 row_mask:0xf bank_mask:0xf
    v_dot2c_f32_bf16_dpp v142, v138, v62 row_newbcast:1 row_mask:0xf bank_mask:0xf
    v_dot2c_f32_bf16_dpp v143, v138, v63 row_newbcast:1 row_mask:0xf bank_mask:0xf
    s_waitcnt vmcnt(26)
    v_perm_b32 v64, v101, v100, s64
    v_perm_b32 v65, v101, v100, s65
    s_waitcnt vmcnt(24)
    v_perm_b32 v66, v103, v102, s64
    v_perm_b32 v67, v103, v102, s65
    v_dot2c_f32_bf16_dpp v140, v138, v64 row_newbcast:2 row_mask:0xf bank_mask:0xf
    v_dot2c_f32_bf16_dpp v141, v138, v65 row_newbcast:2 row_mask:0xf bank_mask:0xf
    v_dot2c_f32_bf16_dpp v142, v138, v66 row_newbcast:3 row_mask:0xf bank_mask:0xf
    v_dot2c_f32_bf16_dpp v143, v138, v67 row_newbcast:3 row_mask:0xf bank_mask:0xf
    s_waitcnt vmcnt(22)
    v_perm_b32 v68, v105, v104, s64
    v_perm_b32 v69, v105, v104, s65
    s_waitcnt vmcnt(20)
    v_perm_b32 v70, v107, v106, s64
    v_perm_b32 v71, v107, v106, s65
    v_dot2c_f32_bf16_dpp v140, v138, v68 row_newbcast:4 row_mask:0xf bank_mask:0xf
    v_dot2c_f32_bf16_dpp v141, v138, v69 row_newbcast:4 row_mask:0xf bank_mask:0xf
    v_dot2c_f32_bf16_dpp v142, v138, v70 row_newbcast:5 row_mask:0xf bank_mask:0xf
    v_dot2c_f32_bf16_dpp v143, v138, v71 row_newbcast:5 row_mask:0xf bank_mask:0xf
    s_waitcnt vmcnt(18)
    v_perm_b32 v72, v109, v108, s64
    v_perm_b32 v73, v109, v108, s65
    s_waitcnt vmcnt(16)
    v_perm_b32 v74, v111, v110, s64
    v_perm_b32 v75, v111, v110, s65
    v_dot2c_f32_bf16_dpp v140, v138, v72 row_newbcast:6 row_mask:0xf bank_mask:0xf
    v_dot2c_f32_bf16_dpp v141, v138, v73 row_newbcast:6 row_mask:0xf bank_mask:0xf
    v_dot2c_f32_bf16_dpp v142, v138, v74 row_newbcast:7 row_mask:0xf bank_mask:0xf
    v_dot2c_f32_bf16_dpp v143, v138, v75 row_newbcast:7 row_mask:0xf bank_mask:0xf
    s_waitcnt vmcnt(14)
    v_perm_b32 v76, v113, v112, s64
    v_perm_b32 v77, v113, v112, s65
    s_waitcnt vmcnt(12)
    v_perm_b32 v78, v115, v114, s64
    v_perm_b32 v79, v115, v114, s65
    v_dot2c_f32_bf16_dpp v140, v138, v76 row_newbcast:8 row_mask:0xf bank_mask:0xf
    v_dot2c_f32_bf16_dpp v141, v138, v77 row_newbcast:8 row_mask:0xf bank_mask:0xf
    v_dot2c_f32_bf16_dpp v142, v138, v78 row_newbcast:9 row_mask:0xf bank_mask:0xf
    v_dot2c_f32_bf16_dpp v143, v138, v79 row_newbcast:9 row_mask:0xf bank_mask:0xf
    s_waitcnt vmcnt(10)
    v_perm_b32 v80, v117, v116, s64
    v_perm_b32 v81, v117, v116, s65
    s_waitcnt vmcnt(8)
    v_perm_b32 v82, v119, v118, s64
    v_perm_b32 v83, v119, v118, s65
    v_dot2c_f32_bf16_dpp v140, v138, v80 row_newbcast:10 row_mask:0xf bank_mask:0xf
    v_dot2c_f32_bf16_dpp v141, v138, v81 row_newbcast:10 row_mask:0xf bank_mask:0xf
    v_dot2c_f32_bf16_dpp v142, v138, v82 row_newbcast:11 row_mask:0xf bank_mask:0xf
    v_dot2c_f32_bf16_dpp v143, v138, v83 row_newbcast:11 row_mask:0xf bank_mask:0xf
    s_waitcnt vmcnt(6)
    v_perm_b32 v84, v121, v120, s64
    v_perm_b32 v85, v121, v120, s65
    s_waitcnt vmcnt(4)
    v_perm_b32 v86, v123, v122, s64
    v_perm_b32 v87, v123, v122, s65
    v_dot2c_f32_bf16_dpp v140, v138, v84 row_newbcast:12 row_mask:0xf bank_mask:0xf
    v_dot2c_f32_bf16_dpp v141, v138, v85 row_newbcast:12 row_mask:0xf bank_mask:0xf
    v_dot2c_f32_bf16_dpp v142, v138, v86 row_newbcast:13 row_mask:0xf bank_mask:0xf
    v_dot2c_f32_bf16_dpp v143, v138, v87 row_newbcast:13 row_mask:0xf bank_mask:0xf
    s_waitcnt vmcnt(2)
    v_perm_b32 v88, v125, v124, s64
    v_perm_b32 v89, v125, v124, s65
    s_waitcnt vmcnt(0)
    v_perm_b32 v90, v127, v126, s64
    v_perm_b32 v91, v127, v126, s65
    v_dot2c_f32_bf16_dpp v140, v138, v88 row_newbcast:14 row_mask:0xf bank_mask:0xf
    v_dot2c_f32_bf16_dpp v141, v138, v89 row_newbcast:14 row_mask:0xf bank_mask:0xf
    v_dot2c_f32_bf16_dpp v142, v138, v90 row_newbcast:15 row_mask:0xf bank_mask:0xf
    v_dot2c_f32_bf16_dpp v143, v138, v91 row_newbcast:15 row_mask:0xf bank_mask:0xf
    s_nop 2
    v_pk_add_f32 v[140:141], v[140:141], v[142:143]
    s_nop 1
    v_permlane32_swap_b32 v140, v141
    v_add_f32 v140, v140, v141
    v_cvt_f64_f32 v[140:141], v140
    ds_add_f64 v129, v[140:141]
    v_lshlrev_b32 v129, 5, v3
    v_add_u32 v129, 158080, v129
    s_lshl_b32 s72, s70, 8
    s_add_u32 s72, s72, 1376256
    s_cmp_lg_u32 s61, 0
    s_waitcnt lgkmcnt(0)
    s_barrier
    s_cbranch_scc1 L_modpub
    ds_read_b128 v[140:143], v129
    ds_read_b128 v[144:147], v129 offset:16
    v_lshlrev_b32 v139, 4, v3
    s_mov_b32 s83, 16384
    v_mad_u32_u24 v139, v2, s83, v139
    s_add_u32 s73, s72, 65536
    s_waitcnt lgkmcnt(0)
    v_cvt_f32_f64 v140, v[140:141]
    v_cvt_f32_f64 v142, v[142:143]
    v_cvt_f32_f64 v144, v[144:145]
    v_cvt_f32_f64 v146, v[146:147]
    v_cvt_pk_bf16_f32 v156, v140, v142
    v_cvt_pk_bf16_f32 v158, v144, v146
    buffer_store_dwordx4 v[156:159], v139, s[16:19], s72 offen sc1
    buffer_store_dwordx4 v[156:159], v139, s[16:19], s73 offen sc1
    s_mov_b64 exec, -1
L_modpub:
    s_cmp_ge_u32 s2, 200
    s_cbranch_scc1 L_mlp
    s_barrier
    s_cmp_ge_u32 s61, 7
    s_cbranch_scc1 L_nodn
    s_and_b32 s66, s2, 7
    s_lshr_b32 s67, s2, 3
    s_sub_u32 s67, s67, 20
    s_lshr_b32 s82, s61, 1
    s_lshl3_add_u32 s82, s82, s66
    s_mul_i32 s82, s82, 10
    s_and_b32 s83, s61, 1
    s_lshl1_add_u32 s83, s67, s83
    s_add_u32 s82, s82, s83
    s_add_u32 s66, s66, 48
    s_mul_i32 s66, s66, 5
    s_add_u32 s66, s66, s67
    s_cmp_eq_u32 s61, 6
    s_cselect_b32 s82, s66, s82
    s_lshl_b32 s82, s82, 13
    v_lshl_add_u32 v165, v1, 7, s82
    buffer_load_dword v163, v165, s[44:47], 0 offen
L_nodn:
    s_cmp_lt_u32 s2, 180
    s_cbranch_scc1 L_keys
    s_cmp_lt_u32 s2, 200
    s_cbranch_scc1 L_end
L_mlp:
    s_barrier
    s_cmp_ge_u32 s61, 8
    s_cbranch_scc1 L_nogul
    buffer_load_dword v72, v134, s[36:39], s74 offen
    buffer_load_dword v73, v134, s[36:39], s74 offen offset:3456
    s_add_u32 s74, s74, 6912
    buffer_load_dword v74, v134, s[36:39], s74 offen
    buffer_load_dword v75, v134, s[36:39], s74 offen offset:3456
    s_add_u32 s74, s74, 6912
    buffer_load_dword v76, v134, s[36:39], s74 offen
    buffer_load_dword v77, v134, s[36:39], s74 offen offset:3456
    s_add_u32 s74, s74, 6912
    buffer_load_dword v78, v134, s[36:39], s74 offen
    buffer_load_dword v79, v134, s[36:39], s74 offen offset:3456
    s_add_u32 s74, s74, 6912
    buffer_load_dword v80, v134, s[36:39], s74 offen
    buffer_load_dword v81, v134, s[36:39], s74 offen offset:3456
    s_add_u32 s74, s74, 6912
    buffer_load_dword v82, v134, s[36:39], s74 offen
    buffer_load_dword v83, v134, s[36:39], s74 offen offset:3456
    s_add_u32 s74, s74, 6912
    buffer_load_dword v84, v134, s[36:39], s74 offen
    buffer_load_dword v85, v134, s[36:39], s74 offen offset:3456
    s_add_u32 s74, s74, 6912
    buffer_load_dword v86, v134, s[36:39], s74 offen
    buffer_load_dword v87, v134, s[36:39], s74 offen offset:3456
    s_add_u32 s74, s74, 6912
    buffer_load_dword v88, v134, s[36:39], s74 offen
    buffer_load_dword v89, v134, s[36:39], s74 offen offset:3456
    s_add_u32 s74, s74, 6912
    buffer_load_dword v90, v134, s[36:39], s74 offen
    buffer_load_dword v91, v134, s[36:39], s74 offen offset:3456
    s_add_u32 s74, s74, 6912
    buffer_load_dword v92, v134, s[36:39], s74 offen
    buffer_load_dword v93, v134, s[36:39], s74 offen offset:3456
    s_add_u32 s74, s74, 6912
    buffer_load_dword v94, v134, s[36:39], s74 offen
    buffer_load_dword v95, v134, s[36:39], s74 offen offset:3456
    s_add_u32 s74, s74, 6912
    buffer_load_dword v96, v134, s[36:39], s74 offen
    buffer_load_dword v97, v134, s[36:39], s74 offen offset:3456
    s_add_u32 s74, s74, 6912
    buffer_load_dword v98, v134, s[36:39], s74 offen
    buffer_load_dword v99, v134, s[36:39], s74 offen offset:3456
    s_add_u32 s74, s74, 6912
    buffer_load_dword v100, v134, s[36:39], s74 offen
    buffer_load_dword v101, v134, s[36:39], s74 offen offset:3456
    s_add_u32 s74, s74, 6912
    buffer_load_dword v102, v134, s[36:39], s74 offen
    buffer_load_dword v103, v134, s[36:39], s74 offen offset:3456
    s_add_u32 s74, s74, 6912
    buffer_load_dword v104, v134, s[36:39], s74 offen
    buffer_load_dword v105, v134, s[36:39], s74 offen offset:3456
    s_add_u32 s74, s74, 6912
    buffer_load_dword v106, v134, s[36:39], s74 offen
    buffer_load_dword v107, v134, s[36:39], s74 offen offset:3456
    s_add_u32 s74, s74, 6912
    buffer_load_dword v108, v134, s[36:39], s74 offen
    buffer_load_dword v109, v134, s[36:39], s74 offen offset:3456
    s_add_u32 s74, s74, 6912
    buffer_load_dword v110, v134, s[36:39], s74 offen
    buffer_load_dword v111, v134, s[36:39], s74 offen offset:3456
L_nogul:
    s_barrier
    buffer_load_dword v112, v135, s[44:47], s76 offen offset:0
    buffer_load_dword v113, v135, s[44:47], s76 offen offset:1280
    buffer_load_dword v114, v135, s[44:47], s76 offen offset:2560
    buffer_load_dword v115, v135, s[44:47], s76 offen offset:3840
    s_add_u32 s76, s76, 5120
    buffer_load_dword v116, v135, s[44:47], s76 offen offset:0
    buffer_load_dword v117, v135, s[44:47], s76 offen offset:1280
    buffer_load_dword v118, v135, s[44:47], s76 offen offset:2560
    buffer_load_dword v119, v135, s[44:47], s76 offen offset:3840
    s_add_u32 s76, s76, 5120
    buffer_load_dword v120, v135, s[44:47], s76 offen offset:0
    buffer_load_dword v121, v135, s[44:47], s76 offen offset:1280
    buffer_load_dword v122, v135, s[44:47], s76 offen offset:2560
    buffer_load_dword v123, v135, s[44:47], s76 offen offset:3840
    s_add_u32 s76, s76, 5120
    buffer_load_dword v124, v135, s[44:47], s76 offen offset:0
    buffer_load_dword v125, v135, s[44:47], s76 offen offset:1280
    buffer_load_dword v126, v135, s[44:47], s76 offen offset:2560
    buffer_load_dword v127, v135, s[44:47], s76 offen offset:3840
    s_add_u32 s76, s76, 5120
    s_waitcnt vmcnt(0)
    v_perm_b32 v32, v73, v72, s64
    v_perm_b32 v33, v73, v72, s65
    v_perm_b32 v34, v75, v74, s64
    v_perm_b32 v35, v75, v74, s65
    v_perm_b32 v36, v77, v76, s64
    v_perm_b32 v37, v77, v76, s65
    v_perm_b32 v38, v79, v78, s64
    v_perm_b32 v39, v79, v78, s65
    v_perm_b32 v40, v81, v80, s64
    v_perm_b32 v41, v81, v80, s65
    v_perm_b32 v42, v83, v82, s64
    v_perm_b32 v43, v83, v82, s65
    v_perm_b32 v44, v85, v84, s64
    v_perm_b32 v45, v85, v84, s65
    v_perm_b32 v46, v87, v86, s64
    v_perm_b32 v47, v87, v86, s65
    v_perm_b32 v48, v89, v88, s64
    v_perm_b32 v49, v89, v88, s65
    v_perm_b32 v50, v91, v90, s64
    v_perm_b32 v51, v91, v90, s65
    v_perm_b32 v52, v93, v92, s64
    v_perm_b32 v53, v93, v92, s65
    v_perm_b32 v54, v95, v94, s64
    v_perm_b32 v55, v95, v94, s65
    v_perm_b32 v56, v97, v96, s64
    v_perm_b32 v57, v97, v96, s65
    v_perm_b32 v58, v99, v98, s64
    v_perm_b32 v59, v99, v98, s65
    v_perm_b32 v60, v101, v100, s64
    v_perm_b32 v61, v101, v100, s65
    v_perm_b32 v62, v103, v102, s64
    v_perm_b32 v63, v103, v102, s65
    v_perm_b32 v64, v105, v104, s64
    v_perm_b32 v65, v105, v104, s65
    v_perm_b32 v66, v107, v106, s64
    v_perm_b32 v67, v107, v106, s65
    v_perm_b32 v68, v109, v108, s64
    v_perm_b32 v69, v109, v108, s65
    v_perm_b32 v70, v111, v110, s64
    v_perm_b32 v71, v111, v110, s65
    v_perm_b32 v12, v113, v112, s64
    v_perm_b32 v13, v113, v112, s65
    v_perm_b32 v14, v115, v114, s64
    v_perm_b32 v15, v115, v114, s65
    v_perm_b32 v16, v117, v116, s64
    v_perm_b32 v17, v117, v116, s65
    v_perm_b32 v18, v119, v118, s64
    v_perm_b32 v19, v119, v118, s65
    v_perm_b32 v20, v121, v120, s64
    v_perm_b32 v21, v121, v120, s65
    v_perm_b32 v22, v123, v122, s64
    v_perm_b32 v23, v123, v122, s65
    v_perm_b32 v24, v125, v124, s64
    v_perm_b32 v25, v125, v124, s65
    v_perm_b32 v26, v127, v126, s64
    v_perm_b32 v27, v127, v126, s65
    v_mov_b32 v140, 0
    v_mov_b32 v141, 0
    v_mov_b32 v142, 0
    v_mov_b32 v143, 0
    v_mov_b32 v144, 0
    v_mov_b32 v145, 0
    v_mov_b32 v146, 0
    v_mov_b32 v147, 0
L_keys:
    s_mov_b32 s74, 8257536
    s_getreg_b32 s57, hwreg(HW_REG_XCC_ID, 2, 1)
    s_mov_b64 exec, 1
    s_mov_b32 s79, 0
L_info_25:
    buffer_load_dwordx2 v[148:149], v11, s[16:19], s74 offen sc1
    s_add_u32 s79, s79, 1
    s_waitcnt vmcnt(0)
    v_readfirstlane_b32 s73, v149
    v_readfirstlane_b32 s72, v148
    s_cmp_eq_u32 s73, s60
    s_cbranch_scc1 L_info_done_26
    s_mov_b32 s72, 0
    s_cmp_lt_u32 s79, 524288
    s_cbranch_scc1 L_info_25
L_info_done_26:
    s_mov_b64 exec, -1
    s_xor_b32 s57, s57, s72
    s_and_b32 s57, s57, 1
    s_lshl_b32 s57, s57, 13
    v_mov_b32 v129, 158848
    s_cmp_lt_u32 s61, 8
    s_cbranch_scc1 L_follow
    s_and_b32 s73, s61, 1
    s_lshl_b32 s72, s73, 3
    v_add_u32 v161, s72, v129
    s_lshl_b32 s72, s73, 15
    s_add_u32 s72, s72, s57
    s_and_b32 s73, s2, 7
    s_mul_i32 s73, s73, 65536
    s_add_u32 s72, s72, s73
    s_add_u32 s72, s72, 6291456
    v_lshlrev_b32 v150, 8, v1
    v_lshl_add_u32 v150, v137, 13, v150
    s_setprio 3
    s_mov_b32 s79, 0
L_keys_27:
    s_add_u32 s79, s79, 1
    buffer_load_dwordx2 v[72:73], v150, s[16:19], s72 offen sc1
    s_mov_b64 s[66:67], exec
    s_waitcnt vmcnt(0)
    v_cmp_ne_u32 vcc, v167, v73
    s_cmp_gt_u32 s79, 524288
    s_cselect_b64 vcc, 0, vcc
    s_andn2_b64 exec, s[66:67], vcc
    s_cbranch_scc0 L_nonew0
    ds_max_u32 v161, v72
    s_bcnt0_i32_b64 s73, vcc
    v_mov_b32 v151, s73
    ds_write_b32 v161, v151 offset:4
L_nonew0:
    s_and_b64 exec, vcc, vcc
    s_cbranch_scc1 L_keys_27
    s_mov_b64 exec, -1
    s_cmp_ge_u32 s2, 200
    s_waitcnt lgkmcnt(0)
    s_cbranch_scc1 L_stage2
L_follow:
    s_cmp_ge_u32 s2, 200
    s_cbranch_scc1 L_spec0
    s_cmp_ge_u32 s61, 7
    s_cbranch_scc1 L_notouch
    s_lshl_b32 s72, s61, 3
    v_add_u32 v12, s72, v2
    v_add_u32 v13, 4, v12
    v_cmp_gt_u32 s[66:67], 54, v13
    v_lshlrev_b32 v14, 4, v3
    s_mov_b32 s83, 16384
    v_mad_u32_u24 v12, v12, s83, v14
    s_mov_b32 s83, 16384
    v_mad_u32_u24 v13, v13, s83, v14
    s_mov_b64 s[68:69], -1
    s_lshl_b32 s72, s70, 8
    s_add_u32 s72, s72, 7340032
    s_add_u32 s72, s72, s57
    s_and_b64 exec, s[68:69], s[68:69]
    s_cbranch_scc0 L_held_29
    buffer_load_dwordx4 v[16:19], v12, s[16:19], s72 offen sc1
L_held_29:
    s_and_b64 exec, s[66:67], s[66:67]
    s_cbranch_scc0 L_held_30
    buffer_load_dwordx4 v[20:23], v13, s[16:19], s72 offen sc1
L_held_30:
    s_mov_b64 exec, -1
L_notouch:
    s_barrier
    ds_read_b128 v[132:135], v129
    s_waitcnt lgkmcnt(0)
    v_max_u32 v132, v132, v134
    s_nop 0
    v_readfirstlane_b32 s74, v132
    s_ashr_i32 s75, s74, 31
    s_xor_b32 s75, s75, s74
    s_bfe_u32 s76, s75, 0x70004
    s_branch L_red
L_spec0:
    v_add_u32 v160, s57, v160
    s_mov_b32 s75, -1
    s_mov_b32 s79, 0
L_spec:
    ds_read_b128 v[132:135], v129
    s_add_u32 s79, s79, 1
    s_cmp_gt_u32 s79, 8388608
    s_cbranch_scc1 L_stage1done
    s_waitcnt lgkmcnt(0)
    v_max_u32 v132, v132, v134
    v_add_u32 v133, v133, v135
L_have:
    v_readfirstlane_b32 s74, v132
    v_readfirstlane_b32 s73, v133
    s_ashr_i32 s76, s74, 31
    s_xor_b32 s76, s76, s74
    s_bfe_u32 s76, s76, 0x70004
    s_cmp_eq_u32 s76, s75
    s_cbranch_scc1 L_same
    s_cmp_lt_u32 s73, 64
    s_cbranch_scc1 L_spec
    s_and_b32 s77, s76, 0x7c
    s_add_u32 s77, s77, s76
    s_lshl_b32 s77, s77, 11
    buffer_load_dwordx2 v[138:139], v160, s[16:19], s77 offen sc1
    v_mov_b32 v140, 0
    v_mov_b32 v141, 0
    v_mov_b32 v142, 0
    v_mov_b32 v143, 0
    s_mov_b32 s75, -1
    s_waitcnt vmcnt(0)
    v_cmp_eq_u32 vcc, s78, v138
    v_cmp_eq_u32 s[66:67], s78, v139
    s_or_b64 vcc, vcc, s[66:67]
    s_cbranch_scc1 L_spec
    s_cmp_eq_u32 s73, 128
    s_cbranch_scc1 L_final
    ds_read_b128 v[132:135], v129
    s_waitcnt lgkmcnt(0)
    v_max_u32 v132, v132, v134
    v_add_u32 v133, v133, v135
    v_cmp_ne_u32 vcc, s74, v132
    v_readfirstlane_b32 s73, v133
    s_cbranch_vccnz L_have
L_final:
    s_mov_b32 s75, s76
    v_dot2c_f32_bf16_dpp v140, v138, v32 row_newbcast:0 row_mask:0xf bank_mask:0xf
    v_dot2c_f32_bf16_dpp v141, v138, v33 row_newbcast:0 row_mask:0xf bank_mask:0xf
    v_dot2c_f32_bf16_dpp v142, v139, v34 row_newbcast:0 row_mask:0xf bank_mask:0xf
    v_dot2c_f32_bf16_dpp v143, v139, v35 row_newbcast:0 row_mask:0xf bank_mask:0xf
    v_dot2c_f32_bf16_dpp v140, v138, v36 row_newbcast:1 row_mask:0xf bank_mask:0xf
    v_dot2c_f32_bf16_dpp v141, v138, v37 row_newbcast:1 row_mask:0xf bank_mask:0xf
    v_dot2c_f32_bf16_dpp v142, v139, v38 row_newbcast:1 row_mask:0xf bank_mask:0xf
    v_dot2c_f32_bf16_dpp v143, v139, v39 row_newbcast:1 row_mask:0xf bank_mask:0xf
    v_dot2c_f32_bf16_dpp v140, v138, v40 row_newbcast:2 row_mask:0xf bank_mask:0xf
    v_dot2c_f32_bf16_dpp v141, v138, v41 row_newbcast:2 row_mask:0xf bank_mask:0xf
    v_dot2c_f32_bf16_dpp v142, v139, v42 row_newbcast:2 row_mask:0xf bank_mask:0xf
    v_dot2c_f32_bf16_dpp v143, v139, v43 row_newbcast:2 row_mask:0xf bank_mask:0xf
    v_dot2c_f32_bf16_dpp v140, v138, v44 row_newbcast:3 row_mask:0xf bank_mask:0xf
    v_dot2c_f32_bf16_dpp v141, v138, v45 row_newbcast:3 row_mask:0xf bank_mask:0xf
    v_dot2c_f32_bf16_dpp v142, v139, v46 row_newbcast:3 row_mask:0xf bank_mask:0xf
    v_dot2c_f32_bf16_dpp v143, v139, v47 row_newbcast:3 row_mask:0xf bank_mask:0xf
    v_dot2c_f32_bf16_dpp v140, v138, v48 row_newbcast:4 row_mask:0xf bank_mask:0xf
    v_dot2c_f32_bf16_dpp v141, v138, v49 row_newbcast:4 row_mask:0xf bank_mask:0xf
    v_dot2c_f32_bf16_dpp v142, v139, v50 row_newbcast:4 row_mask:0xf bank_mask:0xf
    v_dot2c_f32_bf16_dpp v143, v139, v51 row_newbcast:4 row_mask:0xf bank_mask:0xf
    v_dot2c_f32_bf16_dpp v140, v138, v52 row_newbcast:5 row_mask:0xf bank_mask:0xf
    v_dot2c_f32_bf16_dpp v141, v138, v53 row_newbcast:5 row_mask:0xf bank_mask:0xf
    v_dot2c_f32_bf16_dpp v142, v139, v54 row_newbcast:5 row_mask:0xf bank_mask:0xf
    v_dot2c_f32_bf16_dpp v143, v139, v55 row_newbcast:5 row_mask:0xf bank_mask:0xf
    v_dot2c_f32_bf16_dpp v140, v138, v56 row_newbcast:6 row_mask:0xf bank_mask:0xf
    v_dot2c_f32_bf16_dpp v141, v138, v57 row_newbcast:6 row_mask:0xf bank_mask:0xf
    v_dot2c_f32_bf16_dpp v142, v139, v58 row_newbcast:6 row_mask:0xf bank_mask:0xf
    v_dot2c_f32_bf16_dpp v143, v139, v59 row_newbcast:6 row_mask:0xf bank_mask:0xf
    v_dot2c_f32_bf16_dpp v140, v138, v60 row_newbcast:7 row_mask:0xf bank_mask:0xf
    v_dot2c_f32_bf16_dpp v141, v138, v61 row_newbcast:7 row_mask:0xf bank_mask:0xf
    v_dot2c_f32_bf16_dpp v142, v139, v62 row_newbcast:7 row_mask:0xf bank_mask:0xf
    v_dot2c_f32_bf16_dpp v143, v139, v63 row_newbcast:7 row_mask:0xf bank_mask:0xf
    v_dot2c_f32_bf16_dpp v140, v138, v64 row_newbcast:8 row_mask:0xf bank_mask:0xf
    v_dot2c_f32_bf16_dpp v141, v138, v65 row_newbcast:8 row_mask:0xf bank_mask:0xf
    v_dot2c_f32_bf16_dpp v142, v139, v66 row_newbcast:8 row_mask:0xf bank_mask:0xf
    v_dot2c_f32_bf16_dpp v143, v139, v67 row_newbcast:8 row_mask:0xf bank_mask:0xf
    v_dot2c_f32_bf16_dpp v140, v138, v68 row_newbcast:9 row_mask:0xf bank_mask:0xf
    v_dot2c_f32_bf16_dpp v141, v138, v69 row_newbcast:9 row_mask:0xf bank_mask:0xf
    v_dot2c_f32_bf16_dpp v142, v139, v70 row_newbcast:9 row_mask:0xf bank_mask:0xf
    v_dot2c_f32_bf16_dpp v143, v139, v71 row_newbcast:9 row_mask:0xf bank_mask:0xf
    s_nop 2
    v_pk_add_f32 v[140:141], v[140:141], v[142:143]
    s_nop 1
    v_permlane32_swap_b32 v140, v141
    v_add_f32 v140, v140, v141
    v_cvt_f64_f32 v[140:141], v140
L_same:
    s_cmp_lt_u32 s73, 128
    s_cbranch_scc1 L_spec
L_stage1done:
    ds_add_f64 v154, v[140:141]
    s_waitcnt lgkmcnt(0)
L_stage2:
    s_barrier
    ds_read_b128 v[132:135], v155
    s_waitcnt lgkmcnt(0)
    v_cvt_f32_f64 v138, v[132:133]
    v_cvt_f32_f64 v139, v[134:135]
    v_mul_f32 v137, 0xbfb8aa3b, v138
    v_exp_f32 v137, v137
    v_mul_f32 v138, v138, v139
    v_add_f32 v137, 1.0, v137
    v_rcp_f32 v137, v137
    s_nop 0
    v_mul_f32 v138, v138, v137
    s_nop 1
    v_mov_b32_dpp v139, v138 quad_perm:[1,0,3,2] row_mask:0xf bank_mask:0xf
    v_cvt_pk_bf16_f32 v138, v138, v139
    s_nop 1
    v_dot2c_f32_bf16_dpp v144, v138, v12 row_newbcast:0 row_mask:0xf bank_mask:0xf
    v_dot2c_f32_bf16_dpp v145, v138, v13 row_newbcast:0 row_mask:0xf bank_mask:0xf
    v_dot2c_f32_bf16_dpp v146, v138, v14 row_newbcast:2 row_mask:0xf bank_mask:0xf
    v_dot2c_f32_bf16_dpp v147, v138, v15 row_newbcast:2 row_mask:0xf bank_mask:0xf
    v_dot2c_f32_bf16_dpp v144, v138, v16 row_newbcast:4 row_mask:0xf bank_mask:0xf
    v_dot2c_f32_bf16_dpp v145, v138, v17 row_newbcast:4 row_mask:0xf bank_mask:0xf
    v_dot2c_f32_bf16_dpp v146, v138, v18 row_newbcast:6 row_mask:0xf bank_mask:0xf
    v_dot2c_f32_bf16_dpp v147, v138, v19 row_newbcast:6 row_mask:0xf bank_mask:0xf
    v_dot2c_f32_bf16_dpp v144, v138, v20 row_newbcast:8 row_mask:0xf bank_mask:0xf
    v_dot2c_f32_bf16_dpp v145, v138, v21 row_newbcast:8 row_mask:0xf bank_mask:0xf
    v_dot2c_f32_bf16_dpp v146, v138, v22 row_newbcast:10 row_mask:0xf bank_mask:0xf
    v_dot2c_f32_bf16_dpp v147, v138, v23 row_newbcast:10 row_mask:0xf bank_mask:0xf
    v_dot2c_f32_bf16_dpp v144, v138, v24 row_newbcast:12 row_mask:0xf bank_mask:0xf
    v_dot2c_f32_bf16_dpp v145, v138, v25 row_newbcast:12 row_mask:0xf bank_mask:0xf
    v_dot2c_f32_bf16_dpp v146, v138, v26 row_newbcast:14 row_mask:0xf bank_mask:0xf
    v_dot2c_f32_bf16_dpp v147, v138, v27 row_newbcast:14 row_mask:0xf bank_mask:0xf
    s_nop 2
    v_pk_add_f32 v[144:145], v[144:145], v[146:147]
    s_nop 1
    v_permlane32_swap_b32 v144, v145
    v_add_f32 v156, v144, v145
    v_add_f32 v158, v144, v145
    s_nop 1
    v_permlane32_swap_b32 v156, v158
    buffer_store_dwordx4 v[156:159], v162, s[16:19], s81 offen sc1
    s_branch L_end
L_red:
    s_cmp_ge_u32 s61, 7
    s_cbranch_scc1 L_fin
    s_lshl_b32 s72, s61, 3
    v_add_u32 v12, s72, v2
    v_add_u32 v13, 4, v12
    v_cmp_gt_u32 s[66:67], 54, v13
    v_lshlrev_b32 v14, 4, v3
    s_mov_b32 s83, 16384
    v_mad_u32_u24 v12, v12, s83, v14
    s_mov_b32 s83, 16384
    v_mad_u32_u24 v13, v13, s83, v14
    s_mov_b64 s[68:69], -1
    s_lshl_b32 s72, s70, 8
    s_add_u32 s72, s72, 7340032
    s_add_u32 s72, s72, s57
    v_bfe_u32 v15, v0, 5, 1
    v_lshl_add_u32 v14, v15, 3, v14
    v_add_u32 v14, 158592, v14
    s_waitcnt vmcnt(0)
    v_mov_b32 v20, 0
    v_mov_b32 v22, 0
    v_mov_b32 v23, v167
    s_mov_b32 s79, 0
L_part_31:
    s_and_b64 exec, s[68:69], s[68:69]
    s_cbranch_scc0 L_held_33
    buffer_load_dwordx4 v[16:19], v12, s[16:19], s72 offen sc1
L_held_33:
    s_and_b64 exec, s[66:67], s[66:67]
    s_cbranch_scc0 L_held_34
    buffer_load_dwordx4 v[20:23], v13, s[16:19], s72 offen sc1
L_held_34:
    s_mov_b64 exec, -1
    s_add_u32 s79, s79, 1
    s_cmp_gt_u32 s79, 524288
    s_cbranch_scc1 L_part_done_32
    s_waitcnt vmcnt(0)
    v_cmp_ne_u32 s[68:69], v167, v19
    v_cmp_ne_u32 s[66:67], v167, v23
    v_add_f32 v24, v16, v20
    v_add_f32 v25, v18, v22
    s_or_b64 vcc, s[66:67], s[68:69]
    s_cbranch_scc1 L_part_31
L_part_done_32:
    v_permlane32_swap_b32 v24, v25
    v_add_f32 v24, v24, v25
    v_cvt_f64_f32 v[24:25], v24
    ds_add_f64 v14, v[24:25]
    s_waitcnt lgkmcnt(0)
L_redbar:
    s_barrier
    s_branch L_end
L_fin:
    s_cmp_lg_u32 s61, 9
    s_cbranch_scc1 L_redbar
    s_mul_i32 s72, s76, 5120
    s_lshl_b32 s73, s70, 8
    s_add_u32 s72, s72, s73
    s_add_u32 s80, s72, 393216
    s_lshl_b32 s73, s70, 7
    s_add_u32 s81, s73, 1389056
    v_add_u32 v14, 158592, v11
    s_and_b32 s75, s75, 0x7ff
    s_mul_i32 s72, s75, 1280
    s_lshl_b32 s73, s70, 6
    s_add_u32 s82, s72, s73
    v_lshlrev_b32 v15, 2, v3
    s_and_b32 s72, s74, 0xfffff800
    s_or_b32 s72, s72, 0x400
    s_not_b32 s73, s72
    s_xor_b32 s77, s72, 0x80000000
    s_bitcmp1_b32 s72, 31
    s_cselect_b32 s72, s77, s73
    v_mov_b32 v24, s72
    v_mul_f32 v24, 0xbfb8aa3b, v24
    v_exp_f32 v24, v24
    s_nop 0
    v_add_f32 v24, 1.0, v24
    v_rcp_f32 v24, v24
    s_mov_b64 exec, 0xffff
    s_mov_b32 s79, 0
L_base_35:
    buffer_load_dwordx4 v[16:19], v11, s[16:19], s80 offen sc1
    buffer_load_dwordx2 v[20:21], v131, s[16:19], s81 offen sc1
    s_add_u32 s79, s79, 1
    s_cmp_gt_u32 s79, 524288
    s_cbranch_scc1 L_base_done_36
    s_waitcnt vmcnt(0)
    v_cmp_ne_u32 vcc, v167, v17
    v_cmp_ne_u32 s[66:67], v167, v21
    s_or_b64 vcc, vcc, s[66:67]
    s_cbranch_scc1 L_base_35
L_base_done_36:
    s_waitcnt vmcnt(0)
    v_lshlrev_b32 v22, 16, v20
    v_and_b32 v23, v29, v20
    v_mul_f32 v22, v22, v24
    v_mul_f32 v23, v23, v24
    s_barrier
    ds_read_b128 v[32:35], v14
    s_waitcnt lgkmcnt(0)
    v_cvt_f32_f64 v32, v[32:33]
    v_cvt_f32_f64 v33, v[34:35]
    v_fmac_f32 v16, v22, v32
    v_fmac_f32 v18, v23, v33
    v_cvt_pk_bf16_f32 v16, v16, v18
    buffer_store_dword v16, v15, s[24:27], s82 offen sc1
    s_cmp_lg_u32 s70, 0
    s_cbranch_scc1 L_noepoch
    v_mov_b32 v25, 0
    buffer_store_dword v167, v25, s[16:19], 0 offen sc1
L_noepoch:
    s_mov_b64 exec, -1
L_end:
L_exit:
    s_endpgm
L_code_end:
.section .rodata,"a"
.p2align 6
.amdhsa_kernel adaLN_cond__ssm_conv_h3__moe_arch_mod__prompt_kernel
  .amdhsa_next_free_vgpr 168
  .amdhsa_next_free_sgpr 102
  .amdhsa_accum_offset 168
  .amdhsa_group_segment_fixed_size 0
  .amdhsa_kernarg_size 128
  .amdhsa_user_sgpr_count 2
  .amdhsa_user_sgpr_kernarg_segment_ptr 1
  .amdhsa_system_sgpr_workgroup_id_x 1
  .amdhsa_float_denorm_mode_32 3
.end_amdhsa_kernel
```
